```python
import torch

def _softmax(x, axis=-1):
    return torch.softmax(x, dim=axis)
def _gelu(x):
    return torch.nn.functional.gelu(x, approximate="tanh")
def _silu(x):
    return torch.nn.functional.silu(x)
def _sigmoid(x):
    return torch.sigmoid(x)
def _layernorm(x, axis=-1, eps=1e-5):
    m = x.mean(dim=axis, keepdim=True)
    v = x.var(dim=axis, keepdim=True, unbiased=False)
    return (x - m) / torch.sqrt(v + eps)
def _scatter_add(tgt, idx, src, axis=0):
    return tgt.clone().index_add_(axis, idx, src)
def _segment_sum(src, seg, n):
    out = torch.zeros((n,) + src.shape[1:], dtype=src.dtype)
    return out.index_add_(0, seg, src)
def _pad(x, pw):
    flat = tuple(v for pair in reversed(pw) for v in pair)
    return torch.nn.functional.pad(x, flat)

kernel_name = 'gated_mix__linear_attn_block__ssm_conv_h3__prompt'

def setup_inputs():

    _w = (lambda a: (lambda t: t.to(torch.bfloat16) if t.is_floating_point() else t)(torch.as_tensor(a)))
    def _A_setup():
        B, S, D = 1, 2048, 1024
        return {
            "x": _w((lambda *s: torch.randn(*s, dtype=torch.bfloat16) * 0.05)(B, S, D)),
            "wqkv": _w((lambda *s: torch.randn(*s, dtype=torch.bfloat16) * 1.6)(D, 3 * D)),
            "wo": _w((lambda *s: torch.randn(*s, dtype=torch.bfloat16) * 0.05)(D, D)),
        }
    _A_in = _A_setup()

    def _B_setup():
        B, S, D = 1, 2048, 1024
        ks = 4
        return {
            "q": _w((lambda *s: torch.randn(*s, dtype=torch.bfloat16) * 0.05)(B, S, D)),
            "k": _w((lambda *s: torch.randn(*s, dtype=torch.bfloat16) * 0.8)(B, S, D)),
            "v": _w((lambda *s: torch.randn(*s, dtype=torch.bfloat16) * 0.4)(B, S, D)),
            "shift_k": _w((lambda *s: torch.randn(*s, dtype=torch.bfloat16) * 0.8)(D, ks) * 0.5),
            "ssm_k": _w((lambda *s: torch.randn(*s, dtype=torch.bfloat16) * 1.6)(D, S) * (1.0 / S ** 0.5)),
            "ssm_D": _w((lambda *s: torch.randn(*s, dtype=torch.bfloat16) * 0.4)(D)),
        }
    _B_in = _B_setup()

    return {
        "A_x": _A_in["x"],
        "A_wqkv": _A_in["wqkv"],
        "A_wo": _A_in["wo"],
        "B_q": _B_in["q"],
        "B_k": _B_in["k"],
        "B_v": _B_in["v"],
        "B_shift_k": _B_in["shift_k"],
        "B_ssm_k": _B_in["ssm_k"],
        "B_ssm_D": _B_in["ssm_D"],
        "gate_w": _w((lambda *s: torch.randn(*s, dtype=torch.bfloat16) * 0.05)(1024) * 16.0),
    }

def reference(A_x, A_wqkv, A_wo, B_q, B_k, B_v, B_shift_k, B_ssm_k, B_ssm_D, gate_w):
    def _A_ref(x, wqkv, wo):
        B, S, D = x.shape
        H = 32; Dh = D // H
        qkv = (lambda x, *d: x.permute(*d))((x @ wqkv).reshape(B, S, 3, H, Dh), 2, 0, 3, 1, 4)
        q, k, v = qkv[0], qkv[1], qkv[2]
        phi = lambda t: torch.where(t > 0, t + 1, torch.exp(t)) + 1e-6
        pq, pk = phi(q), phi(k)
        kv = torch.einsum("bhsd,bhse->bhde", pk, v)
        z = torch.einsum("bhsd->bhd", pk)
        num = torch.einsum("bhqd,bhde->bhqe", pq, kv)
        den = torch.einsum("bhqd,bhd->bhq", pq, z)[..., None] + 1e-6
        o = num / den
        return (lambda x, *d: x.permute(*d))(o, 0, 2, 1, 3).reshape(B, S, D) @ wo

    def _B_ref(q, k, v, shift_k, ssm_k, ssm_D):
        B, S, D = q.shape
        ks = shift_k.shape[-1]
        k_pad = _pad(k, ((0, 0), (ks - 1, 0), (0, 0)))
        k_shift = torch.zeros_like(k)
        for t in range(ks):
            k_shift = k_shift + k_pad[:, t:t + S, :] * shift_k[:, ks - 1 - t][None, None, :]
        kv = k_shift * v
        L = 2 * S
        kv_pad = _pad(kv, ((0, 0), (0, S), (0, 0)))
        kf_pad = _pad(ssm_k, ((0, 0), (0, S)))
        kv_f = (lambda x, axes=(-2,-1): torch.fft.rfft2(x.float(), dim=axes))(kv_pad[:, None, :, :], axes=(1, 2))
        kf_f = (lambda x, axes=(-2,-1): torch.fft.rfft2(x.float(), dim=axes))(kf_pad[:, None, :], axes=(1, 2))
        kf_f = (lambda x, *d: x.permute(*d))(kf_f, 1, 2, 0)
        y_f = kv_f * kf_f[None, :, :, :]
        y = (lambda x, s, axes=(-2,-1): torch.fft.irfft2(x, s=s, dim=axes).to(torch.bfloat16))(y_f, (1, L), axes=(1, 2))[:, 0, :S, :]
        y = y + kv * ssm_D[None, None, :]
        return q * y

    x = A_x
    g = _sigmoid((x * gate_w).sum(-1, keepdims=True))
    a = _A_ref(x, A_wqkv, A_wo)
    b = _B_ref(x, B_k, B_v, B_shift_k, B_ssm_k, B_ssm_D)
    return g * a + (1 - g) * b
```

```asm
; @launch grid=(256,1,1) block=(512,1,1) lds=163840
.amdgcn_target "amdgcn-amd-amdhsa--gfx950"
.text
.globl gated_mix__linear_attn_block__ssm_conv_h3__prompt_kernel
.p2align 8
.type gated_mix__linear_attn_block__ssm_conv_h3__prompt_kernel,@function
gated_mix__linear_attn_block__ssm_conv_h3__prompt_kernel:
  s_cmp_ge_u32 s2, 256
  s_cbranch_scc1 L_end
  s_load_dwordx16 s[16:31], s[0:1], 0
  s_load_dwordx8 s[32:39], s[0:1], 64
  s_load_dwordx2 s[40:41], s[0:1], 96
  v_lshrrev_b32 v1, 6, v0
  v_and_b32 v250, 63, v0
  s_and_b32 s72, s2, 7
  v_readfirstlane_b32 s64, v1
  s_lshr_b32 s73, s2, 3
  s_and_b32 s65, s72, 1
  s_lshl_b32 s65, s65, 3
  s_and_b32 s74, s73, 7
  s_add_u32 s65, s65, s74
  s_lshr_b32 s66, s72, 1
  s_lshl_b32 s66, s66, 2
  s_lshr_b32 s74, s73, 3
  s_sub_u32 s74, 3, s74
  s_add_u32 s66, s66, s74
  s_and_b32 s69, s72, 3
  s_lshl_b32 s69, s69, 2
  s_and_b32 s74, s73, 3
  s_add_u32 s69, s69, s74
  s_lshr_b32 s70, s72, 2
  s_lshl_b32 s70, s70, 3
  s_lshr_b32 s74, s73, 2
  s_add_u32 s70, s70, s74
  s_add_u32 s43, s66, 4
  s_and_b32 s43, s43, 15
  s_add_u32 s67, s65, s66
  s_and_b32 s67, s67, 15
  s_waitcnt lgkmcnt(0)
  s_mov_b32 s44, s40
  s_and_b32 s45, s41, 0xffff
  s_mov_b32 s46, 0x2000000
  s_mov_b32 s47, 0x20000
  s_cmp_lt_u32 s64, 4
  s_cbranch_scc1 L_compute
  s_cmp_ge_u32 s64, 6
  s_cbranch_scc1 L_prepass
  s_mov_b32 s48, s16
  s_and_b32 s49, s17, 0xffff
  s_mov_b32 s50, 0x400000
  s_mov_b32 s51, 0x20000
  s_mov_b32 s52, s18
  s_and_b32 s53, s19, 0xffff
  s_mov_b32 s54, 0x600000
  s_mov_b32 s55, 0x20000
  s_sub_u32 s71, s64, 4
  v_lshrrev_b32 v5, 3, v250
  v_and_b32 v6, 7, v250
  v_lshrrev_b32 v7, 4, v250
  v_xor_b32 v8, v6, v7
  v_lshlrev_b32 v8, 4, v8
  v_lshlrev_b32 v9, 11, v5
  v_add_u32 v1, v8, v9
  v_xor_b32 v2, 64, v1
  v_and_b32 v7, 1, v7
  v_lshlrev_b32 v7, 1, v7
  v_xor_b32 v8, v6, v7
  v_lshlrev_b32 v8, 4, v8
  v_mul_u32_u24 v9, 6144, v5
  v_add_u32 v3, v8, v9
  v_xor_b32 v4, 64, v3
  s_lshl_b32 s72, s65, 18
  s_lshl_b32 s73, s71, 17
  s_add_u32 s72, s72, s73
  s_lshl_b32 s73, s71, 13
  s_lshl_b32 s74, s71, 12
  s_add_u32 s74, s74, 16384
  s_lshl_b32 s75, s66, 7
  s_mul_i32 s76, s71, 196608
  s_add_u32 s75, s75, s76
  s_lshl_b32 s4, s43, 7
  s_add_u32 s4, s4, s76
  s_mov_b32 s76, 0
  s_mov_b32 s77, 122880
L_ld_loop:
  s_add_u32 s78, s67, s76
  s_and_b32 s78, s78, 15
  s_lshl_b32 s79, s78, 7
  s_add_u32 s79, s79, s72
  s_mul_i32 s80, s78, 393216
  s_add_u32 s5, s80, s4
  s_add_u32 s80, s80, s75
  s_add_u32 s81, s77, s73
  s_add_u32 s82, s77, s74
  s_add_u32 m0, s81, 0
  s_add_u32 s83, s79, 0
  buffer_load_dwordx4 v1, s[48:51], s83 offen  lds
  s_add_u32 m0, s81, 1024
  s_add_u32 s83, s79, 16384
  buffer_load_dwordx4 v2, s[48:51], s83 offen  lds
  s_add_u32 m0, s81, 2048
  s_add_u32 s83, s79, 32768
  buffer_load_dwordx4 v1, s[48:51], s83 offen  lds
  s_add_u32 m0, s81, 3072
  s_add_u32 s83, s79, 49152
  buffer_load_dwordx4 v2, s[48:51], s83 offen  lds
  s_add_u32 m0, s81, 4096
  s_add_u32 s83, s79, 65536
  buffer_load_dwordx4 v1, s[48:51], s83 offen  lds
  s_add_u32 m0, s81, 5120
  s_add_u32 s83, s79, 81920
  buffer_load_dwordx4 v2, s[48:51], s83 offen  lds
  s_add_u32 m0, s81, 6144
  s_add_u32 s83, s79, 98304
  buffer_load_dwordx4 v1, s[48:51], s83 offen  lds
  s_add_u32 m0, s81, 7168
  s_add_u32 s83, s79, 114688
  buffer_load_dwordx4 v2, s[48:51], s83 offen  lds
  s_add_u32 m0, s82, 0
  s_add_u32 s83, s5, 0
  buffer_load_dwordx4 v3, s[52:55], s83 offen  lds
  s_add_u32 m0, s82, 1024
  s_add_u32 s83, s5, 49152
  buffer_load_dwordx4 v4, s[52:55], s83 offen  lds
  s_add_u32 m0, s82, 2048
  s_add_u32 s83, s5, 98304
  buffer_load_dwordx4 v3, s[52:55], s83 offen  lds
  s_add_u32 m0, s82, 3072
  s_add_u32 s83, s5, 147456
  buffer_load_dwordx4 v4, s[52:55], s83 offen  lds
  s_add_u32 m0, s82, 8192
  s_add_u32 s83, s80, 2048
  buffer_load_dwordx4 v3, s[52:55], s83 offen  lds
  s_add_u32 m0, s82, 9216
  s_add_u32 s83, s80, 51200
  buffer_load_dwordx4 v4, s[52:55], s83 offen  lds
  s_add_u32 m0, s82, 10240
  s_add_u32 s83, s80, 100352
  buffer_load_dwordx4 v3, s[52:55], s83 offen  lds
  s_add_u32 m0, s82, 11264
  s_add_u32 s83, s80, 149504
  buffer_load_dwordx4 v4, s[52:55], s83 offen  lds
  s_add_u32 m0, s82, 16384
  s_add_u32 s83, s80, 4096
  buffer_load_dwordx4 v3, s[52:55], s83 offen  lds
  s_add_u32 m0, s82, 17408
  s_add_u32 s83, s80, 53248
  buffer_load_dwordx4 v4, s[52:55], s83 offen  lds
  s_add_u32 m0, s82, 18432
  s_add_u32 s83, s80, 102400
  buffer_load_dwordx4 v3, s[52:55], s83 offen  lds
  s_add_u32 m0, s82, 19456
  s_add_u32 s83, s80, 151552
  buffer_load_dwordx4 v4, s[52:55], s83 offen  lds
  s_add_u32 s76, s76, 1
  s_add_u32 s77, s77, 40960
  s_cmp_eq_u32 s77, 163840
  s_cselect_b32 s77, 0, s77
  s_cmp_lt_u32 s76, 2
  s_cbranch_scc1 L_ld_loop
  s_cmp_eq_u32 s76, 3
  s_cbranch_scc1 L_ld_loop
  s_cmp_eq_u32 s76, 16
  s_cbranch_scc1 L_ld_done
  s_cmp_eq_u32 s76, 2
  s_cbranch_scc1 L_ld_first
  s_waitcnt vmcnt(40)
  s_barrier
  s_branch L_ld_loop
L_ld_first:
  s_waitcnt vmcnt(20)
  s_barrier
  s_branch L_ld_loop
L_ld_done:
  s_waitcnt vmcnt(40)
  s_barrier
  s_mov_b32 s56, s30
  s_and_b32 s57, s31, 0xffff
  s_mov_b32 s58, 0x400000
  s_mov_b32 s59, 0x20000
  s_lshl_b32 s4, s2, 2
  s_add_u32 s4, s4, s64
  s_sub_u32 s4, s4, 4
  s_lshl_b32 s4, s4, 12
  v_lshlrev_b32 v77, 6, v250
  buffer_load_dword v78, v77, s[56:59], s4 offen
  s_waitcnt vmcnt(21)
  s_barrier
  s_waitcnt vmcnt(1)
  s_barrier
  s_mov_b32 s56, s30
  s_and_b32 s57, s31, 0xffff
  s_mov_b32 s58, 0x400000
  s_mov_b32 s59, 0x20000
  s_mov_b32 s60, s32
  s_and_b32 s61, s33, 0xffff
  s_mov_b32 s62, 0x800
  s_mov_b32 s63, 0x20000
  s_lshl_b32 s4, s2, 2
  s_add_u32 s4, s4, s64
  s_sub_u32 s4, s4, 4
  s_lshl_b32 s5, s4, 12
  s_lshl_b32 s6, s4, 1
  v_lshlrev_b32 v74, 4, v250
  v_lshrrev_b32 v75, 4, v250
  v_and_b32 v76, 15, v250
  v_add_u32 v75, v75, v76
  v_subrev_u32 v75, 15, v75
  v_max_i32 v75, 0, v75
  v_lshlrev_b32 v75, 1, v75
  v_mov_b32 v76, 0
  buffer_load_dwordx4 v[48:51], v74, s[56:59], s5 offen offset:0
  buffer_load_dwordx2 v[64:65], v74, s[56:59], s5 offen offset:16
  buffer_load_dwordx4 v[52:55], v74, s[56:59], s5 offen offset:1024
  buffer_load_dwordx2 v[66:67], v74, s[56:59], s5 offen offset:1040
  buffer_load_dwordx4 v[56:59], v74, s[56:59], s5 offen offset:2048
  buffer_load_dwordx2 v[68:69], v74, s[56:59], s5 offen offset:2064
  buffer_load_dwordx4 v[60:63], v74, s[56:59], s5 offen offset:3072
  buffer_load_dwordx2 v[70:71], v74, s[56:59], s5 offen offset:3088
  buffer_load_ushort v72, v75, s[56:59], s5 offen
  buffer_load_ushort v73, v76, s[60:63], s6 offen
  s_mov_b32 s48, s20
  s_and_b32 s49, s21, 0xffff
  s_mov_b32 s50, 0x200000
  s_mov_b32 s51, 0x20000
  s_and_b32 s4, s69, 3
  s_lshl_b32 s4, s4, 1
  s_add_u32 s4, s4, s71
  s_lshl_b32 s4, s4, 18
  s_lshl_b32 s5, s70, 7
  s_add_u32 s4, s4, s5
  s_add_u32 s5, s4, 131072
  v_lshlrev_b32 v77, 11, v250
  buffer_load_dword v78, v77, s[48:51], s4 offen
  buffer_load_dword v79, v77, s[48:51], s5 offen
  s_and_b32 s76, s70, 7
  s_mul_i32 s76, s76, 3
  s_lshr_b32 s76, s76, 1
  s_add_u32 s77, s76, 0
  s_cmp_ge_u32 s77, 12
  s_cselect_b32 s79, 12, 0
  s_sub_u32 s77, s77, s79
  s_mul_i32 s79, s77, 11
  s_lshr_b32 s79, s79, 5
  s_add_u32 s77, s77, s79
  s_lshl_b32 s4, s77, 11
  s_add_u32 s77, s76, 1
  s_cmp_ge_u32 s77, 12
  s_cselect_b32 s79, 12, 0
  s_sub_u32 s77, s77, s79
  s_mul_i32 s79, s77, 11
  s_lshr_b32 s79, s79, 5
  s_add_u32 s77, s77, s79
  s_lshl_b32 s5, s77, 11
  s_add_u32 s77, s76, 2
  s_cmp_ge_u32 s77, 12
  s_cselect_b32 s79, 12, 0
  s_sub_u32 s77, s77, s79
  s_mul_i32 s79, s77, 11
  s_lshr_b32 s79, s79, 5
  s_add_u32 s77, s77, s79
  s_lshl_b32 s6, s77, 11
  s_add_u32 s77, s76, 3
  s_cmp_ge_u32 s77, 12
  s_cselect_b32 s79, 12, 0
  s_sub_u32 s77, s77, s79
  s_mul_i32 s79, s77, 11
  s_lshr_b32 s79, s79, 5
  s_add_u32 s77, s77, s79
  s_lshl_b32 s7, s77, 11
  s_add_u32 s77, s76, 4
  s_cmp_ge_u32 s77, 12
  s_cselect_b32 s79, 12, 0
  s_sub_u32 s77, s77, s79
  s_mul_i32 s79, s77, 11
  s_lshr_b32 s79, s79, 5
  s_add_u32 s77, s77, s79
  s_lshl_b32 s8, s77, 11
  s_add_u32 s77, s76, 5
  s_cmp_ge_u32 s77, 12
  s_cselect_b32 s79, 12, 0
  s_sub_u32 s77, s77, s79
  s_mul_i32 s79, s77, 11
  s_lshr_b32 s79, s79, 5
  s_add_u32 s77, s77, s79
  s_lshl_b32 s9, s77, 11
  s_add_u32 s77, s76, 6
  s_cmp_ge_u32 s77, 12
  s_cselect_b32 s79, 12, 0
  s_sub_u32 s77, s77, s79
  s_mul_i32 s79, s77, 11
  s_lshr_b32 s79, s79, 5
  s_add_u32 s77, s77, s79
  s_lshl_b32 s10, s77, 11
  s_add_u32 s77, s76, 7
  s_cmp_ge_u32 s77, 12
  s_cselect_b32 s79, 12, 0
  s_sub_u32 s77, s77, s79
  s_mul_i32 s79, s77, 11
  s_lshr_b32 s79, s79, 5
  s_add_u32 s77, s77, s79
  s_lshl_b32 s11, s77, 11
  s_add_u32 s77, s76, 8
  s_cmp_ge_u32 s77, 12
  s_cselect_b32 s79, 12, 0
  s_sub_u32 s77, s77, s79
  s_mul_i32 s79, s77, 11
  s_lshr_b32 s79, s79, 5
  s_add_u32 s77, s77, s79
  s_lshl_b32 s12, s77, 11
  s_add_u32 s77, s76, 9
  s_cmp_ge_u32 s77, 12
  s_cselect_b32 s79, 12, 0
  s_sub_u32 s77, s77, s79
  s_mul_i32 s79, s77, 11
  s_lshr_b32 s79, s79, 5
  s_add_u32 s77, s77, s79
  s_lshl_b32 s13, s77, 11
  s_add_u32 s77, s76, 10
  s_cmp_ge_u32 s77, 12
  s_cselect_b32 s79, 12, 0
  s_sub_u32 s77, s77, s79
  s_mul_i32 s79, s77, 11
  s_lshr_b32 s79, s79, 5
  s_add_u32 s77, s77, s79
  s_lshl_b32 s14, s77, 11
  s_add_u32 s77, s76, 11
  s_cmp_ge_u32 s77, 12
  s_cselect_b32 s79, 12, 0
  s_sub_u32 s77, s77, s79
  s_mul_i32 s79, s77, 11
  s_lshr_b32 s79, s79, 5
  s_add_u32 s77, s77, s79
  s_lshl_b32 s15, s77, 11
  s_add_u32 s77, s70, 0
  s_and_b32 s77, s77, 3
  s_lshl_b32 s77, s77, 13
  s_add_u32 s56, s77, 6144
  s_add_u32 s77, s70, 1
  s_and_b32 s77, s77, 3
  s_lshl_b32 s77, s77, 13
  s_add_u32 s57, s77, 6144
  s_add_u32 s77, s70, 2
  s_and_b32 s77, s77, 3
  s_lshl_b32 s77, s77, 13
  s_add_u32 s58, s77, 6144
  s_add_u32 s77, s70, 3
  s_and_b32 s77, s77, 3
  s_lshl_b32 s77, s77, 13
  s_add_u32 s59, s77, 6144
  s_branch L_conv
L_prepass:
  s_mov_b32 s48, s24
  s_and_b32 s49, s25, 0xffff
  s_mov_b32 s50, 0x400000
  s_mov_b32 s51, 0x20000
  s_mov_b32 s52, s26
  s_and_b32 s53, s27, 0xffff
  s_mov_b32 s54, 0x400000
  s_mov_b32 s55, 0x20000
  s_mov_b32 s56, s16
  s_and_b32 s57, s17, 0xffff
  s_mov_b32 s58, 0x400000
  s_mov_b32 s59, 0x20000
  s_sub_u32 s71, s64, 6
  s_mov_b32 s60, s38
  s_and_b32 s61, s39, 0xffff
  s_mov_b32 s62, 0x100
  s_mov_b32 s63, 0x20000
  s_cmp_lg_u32 s2, 0
  s_cbranch_scc1 L_notag
  s_cmp_lg_u32 s71, 0
  s_cbranch_scc1 L_notag
  s_memrealtime s[72:73]
  s_waitcnt lgkmcnt(0)
  s_or_b32 s72, s72, 1
  v_mov_b32 v13, s72
  v_mov_b32 v14, 0
  s_mov_b64 exec, 1
  buffer_store_dword v13, v14, s[60:63], 0 offen sc1
  s_mov_b64 exec, -1
L_notag:
  v_and_b32 v8, 7, v250
  v_lshrrev_b32 v9, 3, v250
  s_lshl_b32 s72, s71, 3
  s_lshl_b32 s73, s65, 4
  s_add_u32 s72, s72, s73
  v_add_u32 v9, s72, v9
  s_lshl_b32 s73, s66, 6
  v_lshlrev_b32 v10, 3, v8
  v_add_u32 v10, s73, v10
  v_lshlrev_b32 v11, 14, v9
  v_lshlrev_b32 v12, 1, v10
  v_add_u32 v3, v11, v12
  v_subrev_u32 v2, 6144, v3
  v_lshlrev_b32 v4, 3, v10
  v_lshlrev_b32 v5, 5, v250
  v_lshlrev_b32 v11, 12, v10
  v_lshlrev_b32 v12, 4, v9
  v_add_u32 v6, v11, v12
  s_mov_b32 s74, 4096
  s_mov_b32 s75, 8192
  s_mov_b32 s76, 12288
  s_lshl_b32 s77, s65, 7
  s_lshl_b32 s78, s66, 3
  s_add_u32 s77, s77, s78
  s_lshl_b32 s78, s71, 2
  s_add_u32 s77, s77, s78
  s_lshl_b32 s78, s77, 11
  s_mov_b32 s8, s28
  s_and_b32 s9, s29, 0xffff
  s_mov_b32 s10, 0x2000
  s_mov_b32 s11, 0x20000
  s_mov_b32 s12, s34
  s_and_b32 s13, s35, 0xffff
  s_mov_b32 s14, 0x800
  s_mov_b32 s15, 0x20000
  s_barrier
  s_barrier
  buffer_load_dwordx4 v[16:19], v2, s[48:51], 0 offen offset:0 nt
  buffer_load_dwordx4 v[20:23], v2, s[48:51], 0 offen offset:2048 nt
  buffer_load_dwordx4 v[24:27], v2, s[48:51], s74 offen offset:0 nt
  buffer_load_dwordx4 v[28:31], v3, s[48:51], 0 offen offset:0 nt
  buffer_load_dwordx4 v[32:35], v3, s[48:51], 0 offen offset:2048 nt
  buffer_load_dwordx4 v[36:39], v3, s[48:51], s74 offen offset:0 nt
  buffer_load_dwordx4 v[40:43], v3, s[48:51], s74 offen offset:2048 nt
  buffer_load_dwordx4 v[44:47], v3, s[48:51], s75 offen offset:0 nt
  buffer_load_dwordx4 v[48:51], v3, s[48:51], s75 offen offset:2048 nt
  buffer_load_dwordx4 v[52:55], v3, s[48:51], s76 offen offset:0 nt
  buffer_load_dwordx4 v[56:59], v3, s[48:51], s76 offen offset:2048 nt
  s_barrier
  buffer_load_dwordx4 v[60:63], v3, s[52:55], 0 offen offset:0 nt
  buffer_load_dwordx4 v[64:67], v3, s[52:55], 0 offen offset:2048 nt
  buffer_load_dwordx4 v[68:71], v3, s[52:55], s74 offen offset:0 nt
  buffer_load_dwordx4 v[72:75], v3, s[52:55], s74 offen offset:2048 nt
  buffer_load_dwordx4 v[76:79], v3, s[52:55], s75 offen offset:0 nt
  buffer_load_dwordx4 v[80:83], v3, s[52:55], s75 offen offset:2048 nt
  buffer_load_dwordx4 v[84:87], v3, s[52:55], s76 offen offset:0 nt
  buffer_load_dwordx4 v[88:91], v3, s[52:55], s76 offen offset:2048 nt
  buffer_load_dwordx4 v[92:95], v4, s[8:11], 0 offen offset:0
  buffer_load_dwordx4 v[96:99], v4, s[8:11], 0 offen offset:16
  buffer_load_dwordx4 v[100:103], v4, s[8:11], 0 offen offset:32
  buffer_load_dwordx4 v[104:107], v4, s[8:11], 0 offen offset:48
  s_barrier
  v_mov_b32 v14, 0
  buffer_load_dword v15, v14, s[60:63], 0 offen sc1
  s_barrier
  s_waitcnt vmcnt(1)
  v_lshlrev_b32 v152, 16, v92
  v_and_b32 v153, 0xffff0000, v92
  v_lshlrev_b32 v154, 16, v93
  v_and_b32 v155, 0xffff0000, v93
  v_lshlrev_b32 v156, 16, v16
  v_lshlrev_b32 v157, 16, v20
  v_lshlrev_b32 v158, 16, v24
  v_lshlrev_b32 v159, 16, v28
  v_lshlrev_b32 v160, 16, v32
  v_lshlrev_b32 v161, 16, v36
  v_lshlrev_b32 v162, 16, v40
  v_lshlrev_b32 v163, 16, v44
  v_lshlrev_b32 v164, 16, v48
  v_lshlrev_b32 v165, 16, v52
  v_lshlrev_b32 v166, 16, v56
  v_mul_f32 v168, v155, v156
  v_mul_f32 v169, v155, v157
  v_mul_f32 v170, v155, v158
  v_mul_f32 v171, v155, v159
  v_mul_f32 v172, v155, v160
  v_mul_f32 v173, v155, v161
  v_mul_f32 v174, v155, v162
  v_mul_f32 v175, v155, v163
  v_fmac_f32 v168, v154, v157
  v_fmac_f32 v169, v154, v158
  v_fmac_f32 v170, v154, v159
  v_fmac_f32 v171, v154, v160
  v_fmac_f32 v172, v154, v161
  v_fmac_f32 v173, v154, v162
  v_fmac_f32 v174, v154, v163
  v_fmac_f32 v175, v154, v164
  v_fmac_f32 v168, v153, v158
  v_fmac_f32 v169, v153, v159
  v_fmac_f32 v170, v153, v160
  v_fmac_f32 v171, v153, v161
  v_fmac_f32 v172, v153, v162
  v_fmac_f32 v173, v153, v163
  v_fmac_f32 v174, v153, v164
  v_fmac_f32 v175, v153, v165
  v_fmac_f32 v168, v152, v159
  v_fmac_f32 v169, v152, v160
  v_fmac_f32 v170, v152, v161
  v_fmac_f32 v171, v152, v162
  v_fmac_f32 v172, v152, v163
  v_fmac_f32 v173, v152, v164
  v_fmac_f32 v174, v152, v165
  v_fmac_f32 v175, v152, v166
  v_lshlrev_b32 v156, 16, v60
  v_lshlrev_b32 v157, 16, v64
  v_lshlrev_b32 v158, 16, v68
  v_lshlrev_b32 v159, 16, v72
  v_lshlrev_b32 v160, 16, v76
  v_lshlrev_b32 v161, 16, v80
  v_lshlrev_b32 v162, 16, v84
  v_lshlrev_b32 v163, 16, v88
  v_mul_f32 v168, v168, v156
  v_mul_f32 v169, v169, v157
  v_mul_f32 v170, v170, v158
  v_mul_f32 v171, v171, v159
  v_mul_f32 v172, v172, v160
  v_mul_f32 v173, v173, v161
  v_mul_f32 v174, v174, v162
  v_mul_f32 v175, v175, v163
  v_cvt_pk_bf16_f32 v176, v175, v174
  v_cvt_pk_bf16_f32 v177, v173, v172
  v_cvt_pk_bf16_f32 v178, v171, v170
  v_cvt_pk_bf16_f32 v179, v169, v168
  s_mov_b32 s80, 0x400000
  buffer_store_dwordx4 v[176:179], v6, s[44:47], s80 offen sc1
  v_lshlrev_b32 v152, 16, v94
  v_and_b32 v153, 0xffff0000, v94
  v_lshlrev_b32 v154, 16, v95
  v_and_b32 v155, 0xffff0000, v95
  v_and_b32 v156, 0xffff0000, v16
  v_and_b32 v157, 0xffff0000, v20
  v_and_b32 v158, 0xffff0000, v24
  v_and_b32 v159, 0xffff0000, v28
  v_and_b32 v160, 0xffff0000, v32
  v_and_b32 v161, 0xffff0000, v36
  v_and_b32 v162, 0xffff0000, v40
  v_and_b32 v163, 0xffff0000, v44
  v_and_b32 v164, 0xffff0000, v48
  v_and_b32 v165, 0xffff0000, v52
  v_and_b32 v166, 0xffff0000, v56
  v_mul_f32 v168, v155, v156
  v_mul_f32 v169, v155, v157
  v_mul_f32 v170, v155, v158
  v_mul_f32 v171, v155, v159
  v_mul_f32 v172, v155, v160
  v_mul_f32 v173, v155, v161
  v_mul_f32 v174, v155, v162
  v_mul_f32 v175, v155, v163
  v_fmac_f32 v168, v154, v157
  v_fmac_f32 v169, v154, v158
  v_fmac_f32 v170, v154, v159
  v_fmac_f32 v171, v154, v160
  v_fmac_f32 v172, v154, v161
  v_fmac_f32 v173, v154, v162
  v_fmac_f32 v174, v154, v163
  v_fmac_f32 v175, v154, v164
  v_fmac_f32 v168, v153, v158
  v_fmac_f32 v169, v153, v159
  v_fmac_f32 v170, v153, v160
  v_fmac_f32 v171, v153, v161
  v_fmac_f32 v172, v153, v162
  v_fmac_f32 v173, v153, v163
  v_fmac_f32 v174, v153, v164
  v_fmac_f32 v175, v153, v165
  v_fmac_f32 v168, v152, v159
  v_fmac_f32 v169, v152, v160
  v_fmac_f32 v170, v152, v161
  v_fmac_f32 v171, v152, v162
  v_fmac_f32 v172, v152, v163
  v_fmac_f32 v173, v152, v164
  v_fmac_f32 v174, v152, v165
  v_fmac_f32 v175, v152, v166
  v_and_b32 v156, 0xffff0000, v60
  v_and_b32 v157, 0xffff0000, v64
  v_and_b32 v158, 0xffff0000, v68
  v_and_b32 v159, 0xffff0000, v72
  v_and_b32 v160, 0xffff0000, v76
  v_and_b32 v161, 0xffff0000, v80
  v_and_b32 v162, 0xffff0000, v84
  v_and_b32 v163, 0xffff0000, v88
  v_mul_f32 v168, v168, v156
  v_mul_f32 v169, v169, v157
  v_mul_f32 v170, v170, v158
  v_mul_f32 v171, v171, v159
  v_mul_f32 v172, v172, v160
  v_mul_f32 v173, v173, v161
  v_mul_f32 v174, v174, v162
  v_mul_f32 v175, v175, v163
  v_cvt_pk_bf16_f32 v180, v175, v174
  v_cvt_pk_bf16_f32 v181, v173, v172
  v_cvt_pk_bf16_f32 v182, v171, v170
  v_cvt_pk_bf16_f32 v183, v169, v168
  s_mov_b32 s80, 0x401000
  buffer_store_dwordx4 v[180:183], v6, s[44:47], s80 offen sc1
  s_barrier
  v_lshlrev_b32 v152, 16, v96
  v_and_b32 v153, 0xffff0000, v96
  v_lshlrev_b32 v154, 16, v97
  v_and_b32 v155, 0xffff0000, v97
  v_lshlrev_b32 v156, 16, v17
  v_lshlrev_b32 v157, 16, v21
  v_lshlrev_b32 v158, 16, v25
  v_lshlrev_b32 v159, 16, v29
  v_lshlrev_b32 v160, 16, v33
  v_lshlrev_b32 v161, 16, v37
  v_lshlrev_b32 v162, 16, v41
  v_lshlrev_b32 v163, 16, v45
  v_lshlrev_b32 v164, 16, v49
  v_lshlrev_b32 v165, 16, v53
  v_lshlrev_b32 v166, 16, v57
  v_mul_f32 v168, v155, v156
  v_mul_f32 v169, v155, v157
  v_mul_f32 v170, v155, v158
  v_mul_f32 v171, v155, v159
  v_mul_f32 v172, v155, v160
  v_mul_f32 v173, v155, v161
  v_mul_f32 v174, v155, v162
  v_mul_f32 v175, v155, v163
  v_fmac_f32 v168, v154, v157
  v_fmac_f32 v169, v154, v158
  v_fmac_f32 v170, v154, v159
  v_fmac_f32 v171, v154, v160
  v_fmac_f32 v172, v154, v161
  v_fmac_f32 v173, v154, v162
  v_fmac_f32 v174, v154, v163
  v_fmac_f32 v175, v154, v164
  v_fmac_f32 v168, v153, v158
  v_fmac_f32 v169, v153, v159
  v_fmac_f32 v170, v153, v160
  v_fmac_f32 v171, v153, v161
  v_fmac_f32 v172, v153, v162
  v_fmac_f32 v173, v153, v163
  v_fmac_f32 v174, v153, v164
  v_fmac_f32 v175, v153, v165
  v_fmac_f32 v168, v152, v159
  v_fmac_f32 v169, v152, v160
  v_fmac_f32 v170, v152, v161
  v_fmac_f32 v171, v152, v162
  v_fmac_f32 v172, v152, v163
  v_fmac_f32 v173, v152, v164
  v_fmac_f32 v174, v152, v165
  v_fmac_f32 v175, v152, v166
  v_lshlrev_b32 v156, 16, v61
  v_lshlrev_b32 v157, 16, v65
  v_lshlrev_b32 v158, 16, v69
  v_lshlrev_b32 v159, 16, v73
  v_lshlrev_b32 v160, 16, v77
  v_lshlrev_b32 v161, 16, v81
  v_lshlrev_b32 v162, 16, v85
  v_lshlrev_b32 v163, 16, v89
  v_mul_f32 v168, v168, v156
  v_mul_f32 v169, v169, v157
  v_mul_f32 v170, v170, v158
  v_mul_f32 v171, v171, v159
  v_mul_f32 v172, v172, v160
  v_mul_f32 v173, v173, v161
  v_mul_f32 v174, v174, v162
  v_mul_f32 v175, v175, v163
  v_cvt_pk_bf16_f32 v176, v175, v174
  v_cvt_pk_bf16_f32 v177, v173, v172
  v_cvt_pk_bf16_f32 v178, v171, v170
  v_cvt_pk_bf16_f32 v179, v169, v168
  s_mov_b32 s80, 0x402000
  buffer_store_dwordx4 v[176:179], v6, s[44:47], s80 offen sc1
  v_lshlrev_b32 v152, 16, v98
  v_and_b32 v153, 0xffff0000, v98
  v_lshlrev_b32 v154, 16, v99
  v_and_b32 v155, 0xffff0000, v99
  v_and_b32 v156, 0xffff0000, v17
  v_and_b32 v157, 0xffff0000, v21
  v_and_b32 v158, 0xffff0000, v25
  v_and_b32 v159, 0xffff0000, v29
  v_and_b32 v160, 0xffff0000, v33
  v_and_b32 v161, 0xffff0000, v37
  v_and_b32 v162, 0xffff0000, v41
  v_and_b32 v163, 0xffff0000, v45
  v_and_b32 v164, 0xffff0000, v49
  v_and_b32 v165, 0xffff0000, v53
  v_and_b32 v166, 0xffff0000, v57
  v_mul_f32 v168, v155, v156
  v_mul_f32 v169, v155, v157
  v_mul_f32 v170, v155, v158
  v_mul_f32 v171, v155, v159
  v_mul_f32 v172, v155, v160
  v_mul_f32 v173, v155, v161
  v_mul_f32 v174, v155, v162
  v_mul_f32 v175, v155, v163
  v_fmac_f32 v168, v154, v157
  v_fmac_f32 v169, v154, v158
  v_fmac_f32 v170, v154, v159
  v_fmac_f32 v171, v154, v160
  v_fmac_f32 v172, v154, v161
  v_fmac_f32 v173, v154, v162
  v_fmac_f32 v174, v154, v163
  v_fmac_f32 v175, v154, v164
  v_fmac_f32 v168, v153, v158
  v_fmac_f32 v169, v153, v159
  v_fmac_f32 v170, v153, v160
  v_fmac_f32 v171, v153, v161
  v_fmac_f32 v172, v153, v162
  v_fmac_f32 v173, v153, v163
  v_fmac_f32 v174, v153, v164
  v_fmac_f32 v175, v153, v165
  v_fmac_f32 v168, v152, v159
  v_fmac_f32 v169, v152, v160
  v_fmac_f32 v170, v152, v161
  v_fmac_f32 v171, v152, v162
  v_fmac_f32 v172, v152, v163
  v_fmac_f32 v173, v152, v164
  v_fmac_f32 v174, v152, v165
  v_fmac_f32 v175, v152, v166
  v_and_b32 v156, 0xffff0000, v61
  v_and_b32 v157, 0xffff0000, v65
  v_and_b32 v158, 0xffff0000, v69
  v_and_b32 v159, 0xffff0000, v73
  v_and_b32 v160, 0xffff0000, v77
  v_and_b32 v161, 0xffff0000, v81
  v_and_b32 v162, 0xffff0000, v85
  v_and_b32 v163, 0xffff0000, v89
  v_mul_f32 v168, v168, v156
  v_mul_f32 v169, v169, v157
  v_mul_f32 v170, v170, v158
  v_mul_f32 v171, v171, v159
  v_mul_f32 v172, v172, v160
  v_mul_f32 v173, v173, v161
  v_mul_f32 v174, v174, v162
  v_mul_f32 v175, v175, v163
  v_cvt_pk_bf16_f32 v180, v175, v174
  v_cvt_pk_bf16_f32 v181, v173, v172
  v_cvt_pk_bf16_f32 v182, v171, v170
  v_cvt_pk_bf16_f32 v183, v169, v168
  s_mov_b32 s80, 0x403000
  buffer_store_dwordx4 v[180:183], v6, s[44:47], s80 offen sc1
  s_barrier
  v_lshlrev_b32 v152, 16, v100
  v_and_b32 v153, 0xffff0000, v100
  v_lshlrev_b32 v154, 16, v101
  v_and_b32 v155, 0xffff0000, v101
  v_lshlrev_b32 v156, 16, v18
  v_lshlrev_b32 v157, 16, v22
  v_lshlrev_b32 v158, 16, v26
  v_lshlrev_b32 v159, 16, v30
  v_lshlrev_b32 v160, 16, v34
  v_lshlrev_b32 v161, 16, v38
  v_lshlrev_b32 v162, 16, v42
  v_lshlrev_b32 v163, 16, v46
  v_lshlrev_b32 v164, 16, v50
  v_lshlrev_b32 v165, 16, v54
  v_lshlrev_b32 v166, 16, v58
  v_mul_f32 v168, v155, v156
  v_mul_f32 v169, v155, v157
  v_mul_f32 v170, v155, v158
  v_mul_f32 v171, v155, v159
  v_mul_f32 v172, v155, v160
  v_mul_f32 v173, v155, v161
  v_mul_f32 v174, v155, v162
  v_mul_f32 v175, v155, v163
  v_fmac_f32 v168, v154, v157
  v_fmac_f32 v169, v154, v158
  v_fmac_f32 v170, v154, v159
  v_fmac_f32 v171, v154, v160
  v_fmac_f32 v172, v154, v161
  v_fmac_f32 v173, v154, v162
  v_fmac_f32 v174, v154, v163
  v_fmac_f32 v175, v154, v164
  v_fmac_f32 v168, v153, v158
  v_fmac_f32 v169, v153, v159
  v_fmac_f32 v170, v153, v160
  v_fmac_f32 v171, v153, v161
  v_fmac_f32 v172, v153, v162
  v_fmac_f32 v173, v153, v163
  v_fmac_f32 v174, v153, v164
  v_fmac_f32 v175, v153, v165
  v_fmac_f32 v168, v152, v159
  v_fmac_f32 v169, v152, v160
  v_fmac_f32 v170, v152, v161
  v_fmac_f32 v171, v152, v162
  v_fmac_f32 v172, v152, v163
  v_fmac_f32 v173, v152, v164
  v_fmac_f32 v174, v152, v165
  v_fmac_f32 v175, v152, v166
  v_lshlrev_b32 v156, 16, v62
  v_lshlrev_b32 v157, 16, v66
  v_lshlrev_b32 v158, 16, v70
  v_lshlrev_b32 v159, 16, v74
  v_lshlrev_b32 v160, 16, v78
  v_lshlrev_b32 v161, 16, v82
  v_lshlrev_b32 v162, 16, v86
  v_lshlrev_b32 v163, 16, v90
  v_mul_f32 v168, v168, v156
  v_mul_f32 v169, v169, v157
  v_mul_f32 v170, v170, v158
  v_mul_f32 v171, v171, v159
  v_mul_f32 v172, v172, v160
  v_mul_f32 v173, v173, v161
  v_mul_f32 v174, v174, v162
  v_mul_f32 v175, v175, v163
  v_cvt_pk_bf16_f32 v176, v175, v174
  v_cvt_pk_bf16_f32 v177, v173, v172
  v_cvt_pk_bf16_f32 v178, v171, v170
  v_cvt_pk_bf16_f32 v179, v169, v168
  s_mov_b32 s80, 0x404000
  buffer_store_dwordx4 v[176:179], v6, s[44:47], s80 offen sc1
  v_lshlrev_b32 v152, 16, v102
  v_and_b32 v153, 0xffff0000, v102
  v_lshlrev_b32 v154, 16, v103
  v_and_b32 v155, 0xffff0000, v103
  v_and_b32 v156, 0xffff0000, v18
  v_and_b32 v157, 0xffff0000, v22
  v_and_b32 v158, 0xffff0000, v26
  v_and_b32 v159, 0xffff0000, v30
  v_and_b32 v160, 0xffff0000, v34
  v_and_b32 v161, 0xffff0000, v38
  v_and_b32 v162, 0xffff0000, v42
  v_and_b32 v163, 0xffff0000, v46
  v_and_b32 v164, 0xffff0000, v50
  v_and_b32 v165, 0xffff0000, v54
  v_and_b32 v166, 0xffff0000, v58
  v_mul_f32 v168, v155, v156
  v_mul_f32 v169, v155, v157
  v_mul_f32 v170, v155, v158
  v_mul_f32 v171, v155, v159
  v_mul_f32 v172, v155, v160
  v_mul_f32 v173, v155, v161
  v_mul_f32 v174, v155, v162
  v_mul_f32 v175, v155, v163
  v_fmac_f32 v168, v154, v157
  v_fmac_f32 v169, v154, v158
  v_fmac_f32 v170, v154, v159
  v_fmac_f32 v171, v154, v160
  v_fmac_f32 v172, v154, v161
  v_fmac_f32 v173, v154, v162
  v_fmac_f32 v174, v154, v163
  v_fmac_f32 v175, v154, v164
  v_fmac_f32 v168, v153, v158
  v_fmac_f32 v169, v153, v159
  v_fmac_f32 v170, v153, v160
  v_fmac_f32 v171, v153, v161
  v_fmac_f32 v172, v153, v162
  v_fmac_f32 v173, v153, v163
  v_fmac_f32 v174, v153, v164
  v_fmac_f32 v175, v153, v165
  v_fmac_f32 v168, v152, v159
  v_fmac_f32 v169, v152, v160
  v_fmac_f32 v170, v152, v161
  v_fmac_f32 v171, v152, v162
  v_fmac_f32 v172, v152, v163
  v_fmac_f32 v173, v152, v164
  v_fmac_f32 v174, v152, v165
  v_fmac_f32 v175, v152, v166
  v_and_b32 v156, 0xffff0000, v62
  v_and_b32 v157, 0xffff0000, v66
  v_and_b32 v158, 0xffff0000, v70
  v_and_b32 v159, 0xffff0000, v74
  v_and_b32 v160, 0xffff0000, v78
  v_and_b32 v161, 0xffff0000, v82
  v_and_b32 v162, 0xffff0000, v86
  v_and_b32 v163, 0xffff0000, v90
  v_mul_f32 v168, v168, v156
  v_mul_f32 v169, v169, v157
  v_mul_f32 v170, v170, v158
  v_mul_f32 v171, v171, v159
  v_mul_f32 v172, v172, v160
  v_mul_f32 v173, v173, v161
  v_mul_f32 v174, v174, v162
  v_mul_f32 v175, v175, v163
  v_cvt_pk_bf16_f32 v180, v175, v174
  v_cvt_pk_bf16_f32 v181, v173, v172
  v_cvt_pk_bf16_f32 v182, v171, v170
  v_cvt_pk_bf16_f32 v183, v169, v168
  s_mov_b32 s80, 0x405000
  buffer_store_dwordx4 v[180:183], v6, s[44:47], s80 offen sc1
  s_barrier
  v_lshlrev_b32 v152, 16, v104
  v_and_b32 v153, 0xffff0000, v104
  v_lshlrev_b32 v154, 16, v105
  v_and_b32 v155, 0xffff0000, v105
  v_lshlrev_b32 v156, 16, v19
  v_lshlrev_b32 v157, 16, v23
  v_lshlrev_b32 v158, 16, v27
  v_lshlrev_b32 v159, 16, v31
  v_lshlrev_b32 v160, 16, v35
  v_lshlrev_b32 v161, 16, v39
  v_lshlrev_b32 v162, 16, v43
  v_lshlrev_b32 v163, 16, v47
  v_lshlrev_b32 v164, 16, v51
  v_lshlrev_b32 v165, 16, v55
  v_lshlrev_b32 v166, 16, v59
  v_mul_f32 v168, v155, v156
  v_mul_f32 v169, v155, v157
  v_mul_f32 v170, v155, v158
  v_mul_f32 v171, v155, v159
  v_mul_f32 v172, v155, v160
  v_mul_f32 v173, v155, v161
  v_mul_f32 v174, v155, v162
  v_mul_f32 v175, v155, v163
  v_fmac_f32 v168, v154, v157
  v_fmac_f32 v169, v154, v158
  v_fmac_f32 v170, v154, v159
  v_fmac_f32 v171, v154, v160
  v_fmac_f32 v172, v154, v161
  v_fmac_f32 v173, v154, v162
  v_fmac_f32 v174, v154, v163
  v_fmac_f32 v175, v154, v164
  v_fmac_f32 v168, v153, v158
  v_fmac_f32 v169, v153, v159
  v_fmac_f32 v170, v153, v160
  v_fmac_f32 v171, v153, v161
  v_fmac_f32 v172, v153, v162
  v_fmac_f32 v173, v153, v163
  v_fmac_f32 v174, v153, v164
  v_fmac_f32 v175, v153, v165
  v_fmac_f32 v168, v152, v159
  v_fmac_f32 v169, v152, v160
  v_fmac_f32 v170, v152, v161
  v_fmac_f32 v171, v152, v162
  v_fmac_f32 v172, v152, v163
  v_fmac_f32 v173, v152, v164
  v_fmac_f32 v174, v152, v165
  v_fmac_f32 v175, v152, v166
  v_lshlrev_b32 v156, 16, v63
  v_lshlrev_b32 v157, 16, v67
  v_lshlrev_b32 v158, 16, v71
  v_lshlrev_b32 v159, 16, v75
  v_lshlrev_b32 v160, 16, v79
  v_lshlrev_b32 v161, 16, v83
  v_lshlrev_b32 v162, 16, v87
  v_lshlrev_b32 v163, 16, v91
  v_mul_f32 v168, v168, v156
  v_mul_f32 v169, v169, v157
  v_mul_f32 v170, v170, v158
  v_mul_f32 v171, v171, v159
  v_mul_f32 v172, v172, v160
  v_mul_f32 v173, v173, v161
  v_mul_f32 v174, v174, v162
  v_mul_f32 v175, v175, v163
  v_cvt_pk_bf16_f32 v176, v175, v174
  v_cvt_pk_bf16_f32 v177, v173, v172
  v_cvt_pk_bf16_f32 v178, v171, v170
  v_cvt_pk_bf16_f32 v179, v169, v168
  s_mov_b32 s80, 0x406000
  buffer_store_dwordx4 v[176:179], v6, s[44:47], s80 offen sc1
  v_lshlrev_b32 v152, 16, v106
  v_and_b32 v153, 0xffff0000, v106
  v_lshlrev_b32 v154, 16, v107
  v_and_b32 v155, 0xffff0000, v107
  v_and_b32 v156, 0xffff0000, v19
  v_and_b32 v157, 0xffff0000, v23
  v_and_b32 v158, 0xffff0000, v27
  v_and_b32 v159, 0xffff0000, v31
  v_and_b32 v160, 0xffff0000, v35
  v_and_b32 v161, 0xffff0000, v39
  v_and_b32 v162, 0xffff0000, v43
  v_and_b32 v163, 0xffff0000, v47
  v_and_b32 v164, 0xffff0000, v51
  v_and_b32 v165, 0xffff0000, v55
  v_and_b32 v166, 0xffff0000, v59
  v_mul_f32 v168, v155, v156
  v_mul_f32 v169, v155, v157
  v_mul_f32 v170, v155, v158
  v_mul_f32 v171, v155, v159
  v_mul_f32 v172, v155, v160
  v_mul_f32 v173, v155, v161
  v_mul_f32 v174, v155, v162
  v_mul_f32 v175, v155, v163
  v_fmac_f32 v168, v154, v157
  v_fmac_f32 v169, v154, v158
  v_fmac_f32 v170, v154, v159
  v_fmac_f32 v171, v154, v160
  v_fmac_f32 v172, v154, v161
  v_fmac_f32 v173, v154, v162
  v_fmac_f32 v174, v154, v163
  v_fmac_f32 v175, v154, v164
  v_fmac_f32 v168, v153, v158
  v_fmac_f32 v169, v153, v159
  v_fmac_f32 v170, v153, v160
  v_fmac_f32 v171, v153, v161
  v_fmac_f32 v172, v153, v162
  v_fmac_f32 v173, v153, v163
  v_fmac_f32 v174, v153, v164
  v_fmac_f32 v175, v153, v165
  v_fmac_f32 v168, v152, v159
  v_fmac_f32 v169, v152, v160
  v_fmac_f32 v170, v152, v161
  v_fmac_f32 v171, v152, v162
  v_fmac_f32 v172, v152, v163
  v_fmac_f32 v173, v152, v164
  v_fmac_f32 v174, v152, v165
  v_fmac_f32 v175, v152, v166
  v_and_b32 v156, 0xffff0000, v63
  v_and_b32 v157, 0xffff0000, v67
  v_and_b32 v158, 0xffff0000, v71
  v_and_b32 v159, 0xffff0000, v75
  v_and_b32 v160, 0xffff0000, v79
  v_and_b32 v161, 0xffff0000, v83
  v_and_b32 v162, 0xffff0000, v87
  v_and_b32 v163, 0xffff0000, v91
  v_mul_f32 v168, v168, v156
  v_mul_f32 v169, v169, v157
  v_mul_f32 v170, v170, v158
  v_mul_f32 v171, v171, v159
  v_mul_f32 v172, v172, v160
  v_mul_f32 v173, v173, v161
  v_mul_f32 v174, v174, v162
  v_mul_f32 v175, v175, v163
  v_cvt_pk_bf16_f32 v180, v175, v174
  v_cvt_pk_bf16_f32 v181, v173, v172
  v_cvt_pk_bf16_f32 v182, v171, v170
  v_cvt_pk_bf16_f32 v183, v169, v168
  s_mov_b32 s80, 0x407000
  buffer_store_dwordx4 v[180:183], v6, s[44:47], s80 offen sc1
  s_barrier
  s_waitcnt vmcnt(8)
  v_readfirstlane_b32 s68, v15
  s_mov_b32 s80, 0
  s_cmp_lg_u32 s68, 0
  s_cbranch_scc1 L_tagok
L_tag_1:
  buffer_load_dword v15, v14, s[60:63], 0 offen sc1
  s_waitcnt vmcnt(0)
  v_readfirstlane_b32 s68, v15
  s_add_u32 s80, s80, 1
  s_cmp_lg_u32 s68, 0
  s_cbranch_scc1 L_tagok
  s_cmp_lt_u32 s80, 200000
  s_cbranch_scc1 L_tag_1
L_tagok:
  s_barrier
  s_waitcnt vmcnt(0)
  s_lshl_b32 s80, s66, 4
  s_add_u32 s80, s80, s65
  s_lshl_b32 s80, s80, 8
  s_add_u32 s80, s80, 0xf00000
  s_lshl_b32 s81, s71, 2
  v_mov_b32 v8, s68
  v_mov_b32 v9, s81
  s_mov_b64 exec, 1
  buffer_store_dword v8, v9, s[44:47], s80 offen sc1
  s_mov_b64 exec, -1
  s_barrier
  s_barrier
  s_barrier
  s_barrier
  s_mov_b32 s42, s77
  s_mov_b32 s48, s30
  s_and_b32 s49, s31, 0xffff
  s_mov_b32 s50, 0x400000
  s_mov_b32 s51, 0x20000
  s_lshl_b32 s4, s2, 2
  s_add_u32 s4, s4, s64
  s_sub_u32 s4, s4, 4
  s_lshl_b32 s4, s4, 12
  v_lshlrev_b32 v77, 6, v250
  buffer_load_dword v78, v77, s[48:51], s4 offen
  v_mov_b32 v16, 0
  v_mov_b32 v17, 0
  v_mov_b32 v18, 0
  v_mov_b32 v19, 0
  v_mov_b32 v12, 163072
  v_mov_b32 v13, s68
  ds_write_b128 v12, v[16:19]
  ds_write_b128 v12, v[16:19] offset:16
  ds_write_b128 v12, v[16:19] offset:32
  ds_write_b128 v12, v[16:19] offset:48
  ds_write_b32 v12, v13 offset:60
  v_lshlrev_b32 v8, 4, v250
  s_mul_i32 s82, s71, 9216
  s_add_u32 s82, s82, 132096
  v_add_u32 v248, s82, v8
  v_and_b32 v9, 31, v250
  v_lshlrev_b32 v9, 4, v9
  v_add_u32 v9, s82, v9
  ds_write_b128 v9, v[16:19]
  ds_write_b128 v9, v[16:19] offset:4608
  v_lshrrev_b32 v9, 2, v250
  v_lshlrev_b32 v10, 8, v9
  v_and_b32 v20, 3, v250
  v_lshlrev_b32 v20, 2, v20
  v_add_u32 v10, v10, v20
  v_lshlrev_b32 v11, 12, v9
  v_add_u32 v11, v11, v20
  s_lshr_b32 s80, s2, 4
  s_lshl_b32 s80, s80, 12
  s_add_u32 s80, s80, 0xf00000
  s_lshl_b32 s81, s69, 8
  s_add_u32 s81, s81, 0xf00000
  s_waitcnt lgkmcnt(0)
  s_barrier
  buffer_load_dword v12, v10, s[44:47], s80 offen sc1
  s_barrier
  s_add_u32 s79, s78, 0
  buffer_load_dwordx4 v[108:111], v5, s[56:59], s79 offen offset:0
  s_add_u32 s79, s78, 0
  buffer_load_dwordx4 v[112:115], v5, s[56:59], s79 offen offset:16
  s_add_u32 s79, s78, 2048
  buffer_load_dwordx4 v[116:119], v5, s[56:59], s79 offen offset:0
  s_add_u32 s79, s78, 2048
  buffer_load_dwordx4 v[120:123], v5, s[56:59], s79 offen offset:16
  s_add_u32 s79, s78, 4096
  buffer_load_dwordx4 v[124:127], v5, s[56:59], s79 offen offset:0
  s_add_u32 s79, s78, 4096
  buffer_load_dwordx4 v[128:131], v5, s[56:59], s79 offen offset:16
  s_add_u32 s79, s78, 6144
  buffer_load_dwordx4 v[132:135], v5, s[56:59], s79 offen offset:0
  s_add_u32 s79, s78, 6144
  buffer_load_dwordx4 v[136:139], v5, s[56:59], s79 offen offset:16
  buffer_load_dwordx4 v[140:143], v5, s[12:15], 0 offen offset:0
  buffer_load_dwordx4 v[144:147], v5, s[12:15], 0 offen offset:16
  s_mov_b32 s56, s30
  s_and_b32 s57, s31, 0xffff
  s_mov_b32 s58, 0x400000
  s_mov_b32 s59, 0x20000
  s_mov_b32 s60, s32
  s_and_b32 s61, s33, 0xffff
  s_mov_b32 s62, 0x800
  s_mov_b32 s63, 0x20000
  s_lshl_b32 s4, s2, 2
  s_add_u32 s4, s4, s64
  s_sub_u32 s4, s4, 4
  s_lshl_b32 s5, s4, 12
  s_lshl_b32 s6, s4, 1
  v_lshlrev_b32 v74, 4, v250
  v_lshrrev_b32 v75, 4, v250
  v_and_b32 v76, 15, v250
  v_add_u32 v75, v75, v76
  v_subrev_u32 v75, 15, v75
  v_max_i32 v75, 0, v75
  v_lshlrev_b32 v75, 1, v75
  v_mov_b32 v76, 0
  buffer_load_dwordx4 v[48:51], v74, s[56:59], s5 offen offset:0
  buffer_load_dwordx2 v[64:65], v74, s[56:59], s5 offen offset:16
  buffer_load_dwordx4 v[52:55], v74, s[56:59], s5 offen offset:1024
  buffer_load_dwordx2 v[66:67], v74, s[56:59], s5 offen offset:1040
  buffer_load_dwordx4 v[56:59], v74, s[56:59], s5 offen offset:2048
  buffer_load_dwordx2 v[68:69], v74, s[56:59], s5 offen offset:2064
  buffer_load_dwordx4 v[60:63], v74, s[56:59], s5 offen offset:3072
  buffer_load_dwordx2 v[70:71], v74, s[56:59], s5 offen offset:3088
  buffer_load_ushort v72, v75, s[56:59], s5 offen
  buffer_load_ushort v73, v76, s[60:63], s6 offen
  s_and_b32 s76, s70, 7
  s_mul_i32 s76, s76, 3
  s_lshr_b32 s76, s76, 1
  s_add_u32 s77, s76, 0
  s_cmp_ge_u32 s77, 12
  s_cselect_b32 s79, 12, 0
  s_sub_u32 s77, s77, s79
  s_mul_i32 s79, s77, 11
  s_lshr_b32 s79, s79, 5
  s_add_u32 s77, s77, s79
  s_lshl_b32 s4, s77, 11
  s_add_u32 s77, s76, 1
  s_cmp_ge_u32 s77, 12
  s_cselect_b32 s79, 12, 0
  s_sub_u32 s77, s77, s79
  s_mul_i32 s79, s77, 11
  s_lshr_b32 s79, s79, 5
  s_add_u32 s77, s77, s79
  s_lshl_b32 s5, s77, 11
  s_add_u32 s77, s76, 2
  s_cmp_ge_u32 s77, 12
  s_cselect_b32 s79, 12, 0
  s_sub_u32 s77, s77, s79
  s_mul_i32 s79, s77, 11
  s_lshr_b32 s79, s79, 5
  s_add_u32 s77, s77, s79
  s_lshl_b32 s6, s77, 11
  s_add_u32 s77, s76, 3
  s_cmp_ge_u32 s77, 12
  s_cselect_b32 s79, 12, 0
  s_sub_u32 s77, s77, s79
  s_mul_i32 s79, s77, 11
  s_lshr_b32 s79, s79, 5
  s_add_u32 s77, s77, s79
  s_lshl_b32 s7, s77, 11
  s_add_u32 s77, s76, 4
  s_cmp_ge_u32 s77, 12
  s_cselect_b32 s79, 12, 0
  s_sub_u32 s77, s77, s79
  s_mul_i32 s79, s77, 11
  s_lshr_b32 s79, s79, 5
  s_add_u32 s77, s77, s79
  s_lshl_b32 s8, s77, 11
  s_add_u32 s77, s76, 5
  s_cmp_ge_u32 s77, 12
  s_cselect_b32 s79, 12, 0
  s_sub_u32 s77, s77, s79
  s_mul_i32 s79, s77, 11
  s_lshr_b32 s79, s79, 5
  s_add_u32 s77, s77, s79
  s_lshl_b32 s9, s77, 11
  s_add_u32 s77, s76, 6
  s_cmp_ge_u32 s77, 12
  s_cselect_b32 s79, 12, 0
  s_sub_u32 s77, s77, s79
  s_mul_i32 s79, s77, 11
  s_lshr_b32 s79, s79, 5
  s_add_u32 s77, s77, s79
  s_lshl_b32 s10, s77, 11
  s_add_u32 s77, s76, 7
  s_cmp_ge_u32 s77, 12
  s_cselect_b32 s79, 12, 0
  s_sub_u32 s77, s77, s79
  s_mul_i32 s79, s77, 11
  s_lshr_b32 s79, s79, 5
  s_add_u32 s77, s77, s79
  s_lshl_b32 s11, s77, 11
  s_add_u32 s77, s76, 8
  s_cmp_ge_u32 s77, 12
  s_cselect_b32 s79, 12, 0
  s_sub_u32 s77, s77, s79
  s_mul_i32 s79, s77, 11
  s_lshr_b32 s79, s79, 5
  s_add_u32 s77, s77, s79
  s_lshl_b32 s12, s77, 11
  s_add_u32 s77, s76, 9
  s_cmp_ge_u32 s77, 12
  s_cselect_b32 s79, 12, 0
  s_sub_u32 s77, s77, s79
  s_mul_i32 s79, s77, 11
  s_lshr_b32 s79, s79, 5
  s_add_u32 s77, s77, s79
  s_lshl_b32 s13, s77, 11
  s_add_u32 s77, s76, 10
  s_cmp_ge_u32 s77, 12
  s_cselect_b32 s79, 12, 0
  s_sub_u32 s77, s77, s79
  s_mul_i32 s79, s77, 11
  s_lshr_b32 s79, s79, 5
  s_add_u32 s77, s77, s79
  s_lshl_b32 s14, s77, 11
  s_add_u32 s77, s76, 11
  s_cmp_ge_u32 s77, 12
  s_cselect_b32 s79, 12, 0
  s_sub_u32 s77, s77, s79
  s_mul_i32 s79, s77, 11
  s_lshr_b32 s79, s79, 5
  s_add_u32 s77, s77, s79
  s_lshl_b32 s15, s77, 11
  s_add_u32 s77, s70, 0
  s_and_b32 s77, s77, 3
  s_lshl_b32 s77, s77, 13
  s_add_u32 s56, s77, 6144
  s_add_u32 s77, s70, 1
  s_and_b32 s77, s77, 3
  s_lshl_b32 s77, s77, 13
  s_add_u32 s57, s77, 6144
  s_add_u32 s77, s70, 2
  s_and_b32 s77, s77, 3
  s_lshl_b32 s77, s77, 13
  s_add_u32 s58, s77, 6144
  s_add_u32 s77, s70, 3
  s_and_b32 s77, s77, 3
  s_lshl_b32 s77, s77, 13
  s_add_u32 s59, s77, 6144
  s_mov_b32 s72, 0x33333333
  s_mov_b32 s73, 0x33333333
  s_waitcnt vmcnt(20)
  v_cmp_eq_u32 vcc, s68, v12
  s_nop 3
  s_and_b64 vcc, vcc, s[72:73]
  s_cmp_eq_u64 vcc, s[72:73]
  s_cbranch_scc1 L_pp_ready
  s_mov_b32 s72, 0x33333333
  s_mov_b32 s73, 0x33333333
  s_mov_b32 s74, 0
L_poll_2:
  buffer_load_dword v12, v10, s[44:47], s80 offen sc1
  s_waitcnt vmcnt(0)
  v_cmp_eq_u32 vcc, s68, v12
  s_add_u32 s74, s74, 1
  s_and_b64 vcc, vcc, s[72:73]
  s_cmp_eq_u64 vcc, s[72:73]
  s_cbranch_scc1 L_pdone_3
  s_cmp_lt_u32 s74, 200000
  s_cbranch_scc1 L_poll_2
L_pdone_3:
L_pp_ready:
  s_lshl_b32 s82, s2, 2
  s_lshl_b32 s83, s71, 1
  s_add_u32 s82, s82, s83
  s_lshl_b32 s82, s82, 12
  s_add_u32 s82, s82, 0x400000
  s_add_u32 s83, s82, 4096
  buffer_load_dwordx4 v[16:19], v8, s[44:47], s82 offen offset:0 sc1
  buffer_load_dwordx4 v[20:23], v8, s[44:47], s82 offen offset:1024 sc1
  buffer_load_dwordx4 v[24:27], v8, s[44:47], s82 offen offset:2048 sc1
  buffer_load_dwordx4 v[28:31], v8, s[44:47], s82 offen offset:3072 sc1
  buffer_load_dwordx4 v[32:35], v8, s[44:47], s83 offen offset:0 sc1
  buffer_load_dwordx4 v[36:39], v8, s[44:47], s83 offen offset:1024 sc1
  buffer_load_dwordx4 v[40:43], v8, s[44:47], s83 offen offset:2048 sc1
  buffer_load_dwordx4 v[44:47], v8, s[44:47], s83 offen offset:3072 sc1
  s_mov_b32 s77, s42
  s_waitcnt vmcnt(18)
  v_mov_b32 v184, 0
  v_mov_b32 v185, 0
  v_mov_b32 v186, 0
  v_mov_b32 v187, 0
  v_dot2_f32_bf16 v184, v108, v140, v184
  v_dot2_f32_bf16 v185, v116, v140, v185
  v_dot2_f32_bf16 v186, v124, v140, v186
  v_dot2_f32_bf16 v187, v132, v140, v187
  v_dot2_f32_bf16 v184, v109, v141, v184
  v_dot2_f32_bf16 v185, v117, v141, v185
  v_dot2_f32_bf16 v186, v125, v141, v186
  v_dot2_f32_bf16 v187, v133, v141, v187
  v_dot2_f32_bf16 v184, v110, v142, v184
  v_dot2_f32_bf16 v185, v118, v142, v185
  v_dot2_f32_bf16 v186, v126, v142, v186
  v_dot2_f32_bf16 v187, v134, v142, v187
  v_dot2_f32_bf16 v184, v111, v143, v184
  v_dot2_f32_bf16 v185, v119, v143, v185
  v_dot2_f32_bf16 v186, v127, v143, v186
  v_dot2_f32_bf16 v187, v135, v143, v187
  v_dot2_f32_bf16 v184, v112, v144, v184
  v_dot2_f32_bf16 v185, v120, v144, v185
  v_dot2_f32_bf16 v186, v128, v144, v186
  v_dot2_f32_bf16 v187, v136, v144, v187
  v_dot2_f32_bf16 v184, v113, v145, v184
  v_dot2_f32_bf16 v185, v121, v145, v185
  v_dot2_f32_bf16 v186, v129, v145, v186
  v_dot2_f32_bf16 v187, v137, v145, v187
  v_dot2_f32_bf16 v184, v114, v146, v184
  v_dot2_f32_bf16 v185, v122, v146, v185
  v_dot2_f32_bf16 v186, v130, v146, v186
  v_dot2_f32_bf16 v187, v138, v146, v187
  v_dot2_f32_bf16 v184, v115, v147, v184
  v_dot2_f32_bf16 v185, v123, v147, v185
  v_dot2_f32_bf16 v186, v131, v147, v186
  v_dot2_f32_bf16 v187, v139, v147, v187
  s_nop 1
  v_add_f32_dpp v184, v184, v184 row_shr:1 row_mask:0xf bank_mask:0xf
  v_add_f32_dpp v185, v185, v185 row_shr:1 row_mask:0xf bank_mask:0xf
  v_add_f32_dpp v186, v186, v186 row_shr:1 row_mask:0xf bank_mask:0xf
  v_add_f32_dpp v187, v187, v187 row_shr:1 row_mask:0xf bank_mask:0xf
  s_nop 1
  v_add_f32_dpp v184, v184, v184 row_shr:2 row_mask:0xf bank_mask:0xf
  v_add_f32_dpp v185, v185, v185 row_shr:2 row_mask:0xf bank_mask:0xf
  v_add_f32_dpp v186, v186, v186 row_shr:2 row_mask:0xf bank_mask:0xf
  v_add_f32_dpp v187, v187, v187 row_shr:2 row_mask:0xf bank_mask:0xf
  s_nop 1
  v_add_f32_dpp v184, v184, v184 row_shr:4 row_mask:0xf bank_mask:0xf
  v_add_f32_dpp v185, v185, v185 row_shr:4 row_mask:0xf bank_mask:0xf
  v_add_f32_dpp v186, v186, v186 row_shr:4 row_mask:0xf bank_mask:0xf
  v_add_f32_dpp v187, v187, v187 row_shr:4 row_mask:0xf bank_mask:0xf
  s_nop 1
  v_add_f32_dpp v184, v184, v184 row_shr:8 row_mask:0xf bank_mask:0xf
  v_add_f32_dpp v185, v185, v185 row_shr:8 row_mask:0xf bank_mask:0xf
  v_add_f32_dpp v186, v186, v186 row_shr:8 row_mask:0xf bank_mask:0xf
  v_add_f32_dpp v187, v187, v187 row_shr:8 row_mask:0xf bank_mask:0xf
  s_nop 1
  v_add_f32_dpp v184, v184, v184 row_bcast:15 row_mask:0xa bank_mask:0xf
  v_add_f32_dpp v185, v185, v185 row_bcast:15 row_mask:0xa bank_mask:0xf
  v_add_f32_dpp v186, v186, v186 row_bcast:15 row_mask:0xa bank_mask:0xf
  v_add_f32_dpp v187, v187, v187 row_bcast:15 row_mask:0xa bank_mask:0xf
  s_nop 1
  v_add_f32_dpp v184, v184, v184 row_bcast:31 row_mask:0xc bank_mask:0xf
  v_add_f32_dpp v185, v185, v185 row_bcast:31 row_mask:0xc bank_mask:0xf
  v_add_f32_dpp v186, v186, v186 row_bcast:31 row_mask:0xc bank_mask:0xf
  v_add_f32_dpp v187, v187, v187 row_bcast:31 row_mask:0xc bank_mask:0xf
  s_mov_b32 s80, 0xbfb8aa3b
  v_mul_f32 v184, s80, v184
  v_mul_f32 v185, s80, v185
  v_mul_f32 v186, s80, v186
  v_mul_f32 v187, s80, v187
  v_exp_f32 v184, v184
  v_exp_f32 v185, v185
  v_exp_f32 v186, v186
  v_exp_f32 v187, v187
  s_nop 0
  v_add_f32 v184, 1.0, v184
  v_add_f32 v185, 1.0, v185
  v_add_f32 v186, 1.0, v186
  v_add_f32 v187, 1.0, v187
  v_rcp_f32 v184, v184
  v_rcp_f32 v185, v185
  v_rcp_f32 v186, v186
  v_rcp_f32 v187, v187
  s_lshl_b32 s80, s77, 2
  s_add_u32 s80, s80, 0xe80000
  v_mov_b32 v188, 0
  v_cmp_eq_u32 vcc, 63, v250
  s_and_saveexec_b64 s[82:83], vcc
  buffer_store_dwordx4 v[184:187], v188, s[44:47], s80 offen sc1
  s_mov_b64 exec, s[82:83]
L_conv:
  s_sub_u32 s71, s64, 4
  s_lshl_b32 s72, s2, 2
  s_add_u32 s72, s72, s71
  s_mul_i32 s73, s71, 16640
  s_lshl_b32 s74, s72, 12
  v_lshlrev_b32 v1, 4, v250
  v_lshrrev_b32 v2, 4, v250
  v_and_b32 v3, 15, v250
  v_add_u32 v4, v2, v3
  v_subrev_u32 v4, 15, v4
  v_add_u32 v5, s73, v1
  v_mov_b32 v10, 0
  v_mul_u32_u24 v14, 4160, v2
  v_lshlrev_b32 v15, 1, v3
  v_add_u32 v14, v14, v15
  v_add_u32 v14, s73, v14
  v_and_b32 v6, 3, v3
  v_mul_u32_u24 v6, 4160, v6
  v_lshlrev_b32 v7, 4, v2
  v_add_u32 v6, v6, v7
  v_lshrrev_b32 v7, 2, v3
  v_lshlrev_b32 v7, 3, v7
  v_add_u32 v6, v6, v7
  v_add_u32 v164, s73, v6
  v_lshlrev_b32 v6, 1, v3
  v_add_u32 v6, 1, v6
  v_sub_u32 v6, v6, v2
  v_lshlrev_b32 v6, 4, v6
  s_mul_i32 s75, s71, 4608
  s_add_u32 s75, s75, 132160
  v_add_u32 v165, s75, v6
  v_lshlrev_b32 v6, 5, v3
  v_lshlrev_b32 v7, 3, v2
  v_add_u32 v166, v6, v7
  v_mov_b32 v9, 163072
  ds_read_b32 v11, v9 offset:60
  s_waitcnt vmcnt(0)
  s_cmp_lt_u32 s71, 2
  s_cbranch_scc1 L_conv_nou
  ds_write_b128 v248, v[16:19] offset:512
  ds_write_b128 v248, v[20:23] offset:1536
  ds_write_b128 v248, v[24:27] offset:2560
  ds_write_b128 v248, v[28:31] offset:3584
  ds_write_b128 v248, v[32:35] offset:5120
  ds_write_b128 v248, v[36:39] offset:6144
  ds_write_b128 v248, v[40:43] offset:7168
  ds_write_b128 v248, v[44:47] offset:8192
  v_mov_b32 v12, 1
  s_waitcnt lgkmcnt(0)
  s_mov_b64 exec, 1
  ds_add_u32 v9, v12 offset:28
  s_mov_b64 exec, -1
  s_lshl_b32 s76, s65, 4
  s_add_u32 s76, s76, s66
  s_lshl_b32 s76, s76, 8
  s_add_u32 s76, s76, 0xf40000
  s_sub_u32 s77, s71, 2
  s_lshl_b32 s77, s77, 2
  v_mov_b32 v12, s68
  v_mov_b32 v13, s77
  s_mov_b64 exec, 1
  buffer_store_dword v12, v13, s[44:47], s76 offen sc1
  s_mov_b64 exec, -1
L_conv_nou:
  v_alignbit_b32 v76, v49, v48, 16
  v_alignbit_b32 v77, v50, v49, 16
  v_alignbit_b32 v78, v51, v50, 16
  v_alignbit_b32 v79, v64, v51, 16
  v_mov_b32 v80, v49
  v_mov_b32 v81, v50
  v_mov_b32 v82, v51
  v_mov_b32 v83, v64
  v_alignbit_b32 v84, v50, v49, 16
  v_alignbit_b32 v85, v51, v50, 16
  v_alignbit_b32 v86, v64, v51, 16
  v_alignbit_b32 v87, v65, v64, 16
  v_mov_b32 v88, v50
  v_mov_b32 v89, v51
  v_mov_b32 v90, v64
  v_mov_b32 v91, v65
  ds_write_b128 v5, v[76:79] offset:32
  ds_write_b128 v5, v[80:83] offset:4192
  ds_write_b128 v5, v[84:87] offset:8352
  ds_write_b128 v5, v[88:91] offset:12512
  v_alignbit_b32 v92, v53, v52, 16
  v_alignbit_b32 v93, v54, v53, 16
  v_alignbit_b32 v94, v55, v54, 16
  v_alignbit_b32 v95, v66, v55, 16
  v_mov_b32 v96, v53
  v_mov_b32 v97, v54
  v_mov_b32 v98, v55
  v_mov_b32 v99, v66
  v_alignbit_b32 v100, v54, v53, 16
  v_alignbit_b32 v101, v55, v54, 16
  v_alignbit_b32 v102, v66, v55, 16
  v_alignbit_b32 v103, v67, v66, 16
  v_mov_b32 v104, v54
  v_mov_b32 v105, v55
  v_mov_b32 v106, v66
  v_mov_b32 v107, v67
  ds_write_b128 v5, v[92:95] offset:1056
  ds_write_b128 v5, v[96:99] offset:5216
  ds_write_b128 v5, v[100:103] offset:9376
  ds_write_b128 v5, v[104:107] offset:13536
  v_alignbit_b32 v76, v57, v56, 16
  v_alignbit_b32 v77, v58, v57, 16
  v_alignbit_b32 v78, v59, v58, 16
  v_alignbit_b32 v79, v68, v59, 16
  v_mov_b32 v80, v57
  v_mov_b32 v81, v58
  v_mov_b32 v82, v59
  v_mov_b32 v83, v68
  v_alignbit_b32 v84, v58, v57, 16
  v_alignbit_b32 v85, v59, v58, 16
  v_alignbit_b32 v86, v68, v59, 16
  v_alignbit_b32 v87, v69, v68, 16
  v_mov_b32 v88, v58
  v_mov_b32 v89, v59
  v_mov_b32 v90, v68
  v_mov_b32 v91, v69
  ds_write_b128 v5, v[76:79] offset:2080
  ds_write_b128 v5, v[80:83] offset:6240
  ds_write_b128 v5, v[84:87] offset:10400
  ds_write_b128 v5, v[88:91] offset:14560
  v_alignbit_b32 v92, v61, v60, 16
  v_alignbit_b32 v93, v62, v61, 16
  v_alignbit_b32 v94, v63, v62, 16
  v_alignbit_b32 v95, v70, v63, 16
  v_mov_b32 v96, v61
  v_mov_b32 v97, v62
  v_mov_b32 v98, v63
  v_mov_b32 v99, v70
  v_alignbit_b32 v100, v62, v61, 16
  v_alignbit_b32 v101, v63, v62, 16
  v_alignbit_b32 v102, v70, v63, 16
  v_alignbit_b32 v103, v71, v70, 16
  v_mov_b32 v104, v62
  v_mov_b32 v105, v63
  v_mov_b32 v106, v70
  v_mov_b32 v107, v71
  ds_write_b128 v5, v[92:95] offset:3104
  ds_write_b128 v5, v[96:99] offset:7264
  ds_write_b128 v5, v[100:103] offset:11424
  ds_write_b128 v5, v[104:107] offset:15584
  v_cmp_gt_i32 vcc, 0, v4
  v_sub_u32 v16, 15, v3
  v_lshrrev_b32 v17, 3, v16
  v_cndmask_b32 v6, v72, v10, vcc
  v_and_b32 v18, 1, v16
  v_lshlrev_b32 v18, 4, v18
  v_lshlrev_b32 v8, v18, v73
  v_cmp_eq_u32 vcc, v17, v2
  ds_write_b16 v14, v6
  v_bfe_u32 v19, v16, 1, 2
  v_cndmask_b32 v8, v10, v8, vcc
  v_cmp_eq_u32 vcc, 0, v19
  s_nop 1
  v_cndmask_b32 v160, v10, v8, vcc
  v_cmp_eq_u32 vcc, 1, v19
  s_nop 1
  v_cndmask_b32 v161, v10, v8, vcc
  v_cmp_eq_u32 vcc, 2, v19
  s_nop 1
  v_cndmask_b32 v162, v10, v8, vcc
  v_cmp_eq_u32 vcc, 3, v19
  s_nop 1
  v_cndmask_b32 v163, v10, v8, vcc
  s_waitcnt lgkmcnt(0)
  v_readfirstlane_b32 s68, v11
  s_mov_b32 s77, 0
L_lp_4:
  ds_read_b32 v12, v9 offset:28
  s_waitcnt lgkmcnt(0)
  v_readfirstlane_b32 s76, v12
  s_add_u32 s77, s77, 1
  s_cmp_ge_u32 s76, 2
  s_cbranch_scc1 L_lpd_5
  s_cmp_lt_u32 s77, 3200000
  s_cbranch_scc1 L_lp_4
L_lpd_5:
  s_mov_b32 s48, s20
  s_and_b32 s49, s21, 0xffff
  s_mov_b32 s50, 0x200000
  s_mov_b32 s51, 0x20000
  v_lshrrev_b32 v4, 3, v250
  v_and_b32 v5, 7, v250
  v_bfe_u32 v6, v250, 4, 2
  v_lshlrev_b32 v6, 1, v6
  v_xor_b32 v5, v5, v6
  v_lshlrev_b32 v5, 4, v5
  v_lshlrev_b32 v4, 11, v4
  v_add_u32 v167, v4, v5
  s_mov_b32 s83, s72
  s_lshl_b32 s72, s70, 7
  s_lshl_b32 s73, s71, 15
  s_add_u32 s72, s72, s73
  s_lshl_b32 s73, s71, 11
  s_mov_b32 s82, s74
  s_mov_b32 s77, 0
L_lp_6:
  ds_read_b32 v12, v9 offset:40
  s_waitcnt lgkmcnt(0)
  v_readfirstlane_b32 s76, v12
  s_add_u32 s77, s77, 1
  s_cmp_ge_u32 s76, 4
  s_cbranch_scc1 L_lpd_7
  s_cmp_lt_u32 s77, 3200000
  s_cbranch_scc1 L_lp_6
L_lpd_7:
  s_lshl_b32 s74, s4, 6
  s_add_u32 m0, s73, 66560
  s_add_u32 s74, s74, s72
  buffer_load_dwordx4 v167, s[48:51], s74 offen  lds
  s_add_u32 m0, s73, 67584
  s_add_u32 s75, s74, 16384
  buffer_load_dwordx4 v167, s[48:51], s75 offen  lds
  s_lshl_b32 s74, s5, 6
  s_add_u32 m0, s73, 74752
  s_add_u32 s74, s74, s72
  buffer_load_dwordx4 v167, s[48:51], s74 offen  lds
  s_add_u32 m0, s73, 75776
  s_add_u32 s75, s74, 16384
  buffer_load_dwordx4 v167, s[48:51], s75 offen  lds
  s_lshl_b32 s74, s6, 6
  s_add_u32 m0, s73, 82944
  s_add_u32 s74, s74, s72
  buffer_load_dwordx4 v167, s[48:51], s74 offen  lds
  s_add_u32 m0, s73, 83968
  s_add_u32 s75, s74, 16384
  buffer_load_dwordx4 v167, s[48:51], s75 offen  lds
  s_lshl_b32 s74, s7, 6
  s_add_u32 m0, s73, 91136
  s_add_u32 s74, s74, s72
  buffer_load_dwordx4 v167, s[48:51], s74 offen  lds
  s_add_u32 m0, s73, 92160
  s_add_u32 s75, s74, 16384
  buffer_load_dwordx4 v167, s[48:51], s75 offen  lds
  s_lshl_b32 s74, s8, 6
  s_add_u32 m0, s73, 99328
  s_add_u32 s74, s74, s72
  buffer_load_dwordx4 v167, s[48:51], s74 offen  lds
  s_add_u32 m0, s73, 100352
  s_add_u32 s75, s74, 16384
  buffer_load_dwordx4 v167, s[48:51], s75 offen  lds
  s_lshl_b32 s74, s9, 6
  s_add_u32 m0, s73, 107520
  s_add_u32 s74, s74, s72
  buffer_load_dwordx4 v167, s[48:51], s74 offen  lds
  s_add_u32 m0, s73, 108544
  s_add_u32 s75, s74, 16384
  buffer_load_dwordx4 v167, s[48:51], s75 offen  lds
  s_lshl_b32 s74, s10, 6
  s_add_u32 m0, s73, 115712
  s_add_u32 s74, s74, s72
  buffer_load_dwordx4 v167, s[48:51], s74 offen  lds
  s_add_u32 m0, s73, 116736
  s_add_u32 s75, s74, 16384
  buffer_load_dwordx4 v167, s[48:51], s75 offen  lds
  s_lshl_b32 s74, s11, 6
  s_add_u32 m0, s73, 123904
  s_add_u32 s74, s74, s72
  buffer_load_dwordx4 v167, s[48:51], s74 offen  lds
  s_add_u32 m0, s73, 124928
  s_add_u32 s75, s74, 16384
  buffer_load_dwordx4 v167, s[48:51], s75 offen  lds
  ds_read_b128 v[64:67], v165 offset:448
  ds_read_b64 v[32:33], v164 offset:0
  ds_read_b64 v[34:35], v164 offset:8
  ds_read_b128 v[68:71], v165 offset:960
  ds_read_b64 v[36:37], v164 offset:512
  ds_read_b64 v[38:39], v164 offset:520
  ds_read_b128 v[72:75], v165 offset:1472
  ds_read_b64 v[40:41], v164 offset:1024
  ds_read_b64 v[42:43], v164 offset:1032
  ds_read_b128 v[76:79], v165 offset:1984
  ds_read_b64 v[44:45], v164 offset:1536
  ds_read_b64 v[46:47], v164 offset:1544
  ds_read_b128 v[80:83], v165 offset:2496
  ds_read_b64 v[48:49], v164 offset:2048
  ds_read_b64 v[50:51], v164 offset:2056
  ds_read_b128 v[84:87], v165 offset:3008
  ds_read_b64 v[52:53], v164 offset:2560
  ds_read_b64 v[54:55], v164 offset:2568
  ds_read_b128 v[88:91], v165 offset:3520
  ds_read_b64 v[56:57], v164 offset:3072
  ds_read_b64 v[58:59], v164 offset:3080
  ds_read_b128 v[92:95], v165 offset:4032
  ds_read_b64 v[60:61], v164 offset:3584
  ds_read_b64 v[62:63], v164 offset:3592
  s_waitcnt lgkmcnt(0)
  v_mfma_f32_16x16x32_bf16 v[0:3], v[32:35], v[64:67], 0
  ds_read_b128 v[128:131], v165 offset:384
  v_mfma_f32_16x16x32_bf16 v[0:3], v[160:163], v[64:67], v[0:3]
  ds_read_b64 v[96:97], v164 offset:64
  v_mfma_f32_16x16x32_bf16 v[4:7], v[32:35], v[68:71], 0
  ds_read_b64 v[98:99], v164 offset:72
  v_mfma_f32_16x16x32_bf16 v[4:7], v[36:39], v[64:67], v[4:7]
  ds_read_b128 v[132:135], v165 offset:896
  v_mfma_f32_16x16x32_bf16 v[4:7], v[160:163], v[68:71], v[4:7]
  ds_read_b64 v[100:101], v164 offset:576
  v_mfma_f32_16x16x32_bf16 v[8:11], v[32:35], v[72:75], 0
  ds_read_b64 v[102:103], v164 offset:584
  v_mfma_f32_16x16x32_bf16 v[8:11], v[36:39], v[68:71], v[8:11]
  ds_read_b128 v[136:139], v165 offset:1408
  v_mfma_f32_16x16x32_bf16 v[8:11], v[40:43], v[64:67], v[8:11]
  ds_read_b64 v[104:105], v164 offset:1088
  v_mfma_f32_16x16x32_bf16 v[8:11], v[160:163], v[72:75], v[8:11]
  ds_read_b64 v[106:107], v164 offset:1096
  v_mfma_f32_16x16x32_bf16 v[12:15], v[32:35], v[76:79], 0
  ds_read_b128 v[140:143], v165 offset:1920
  v_mfma_f32_16x16x32_bf16 v[12:15], v[36:39], v[72:75], v[12:15]
  ds_read_b64 v[108:109], v164 offset:1600
  v_mfma_f32_16x16x32_bf16 v[12:15], v[40:43], v[68:71], v[12:15]
  ds_read_b64 v[110:111], v164 offset:1608
  v_mfma_f32_16x16x32_bf16 v[12:15], v[44:47], v[64:67], v[12:15]
  ds_read_b128 v[144:147], v165 offset:2432
  v_mfma_f32_16x16x32_bf16 v[12:15], v[160:163], v[76:79], v[12:15]
  ds_read_b64 v[112:113], v164 offset:2112
  v_mfma_f32_16x16x32_bf16 v[16:19], v[32:35], v[80:83], 0
  ds_read_b64 v[114:115], v164 offset:2120
  v_mfma_f32_16x16x32_bf16 v[16:19], v[36:39], v[76:79], v[16:19]
  ds_read_b128 v[148:151], v165 offset:2944
  v_mfma_f32_16x16x32_bf16 v[16:19], v[40:43], v[72:75], v[16:19]
  ds_read_b64 v[116:117], v164 offset:2624
  v_mfma_f32_16x16x32_bf16 v[16:19], v[44:47], v[68:71], v[16:19]
  ds_read_b64 v[118:119], v164 offset:2632
  v_mfma_f32_16x16x32_bf16 v[16:19], v[48:51], v[64:67], v[16:19]
  ds_read_b128 v[152:155], v165 offset:3456
  v_mfma_f32_16x16x32_bf16 v[16:19], v[160:163], v[80:83], v[16:19]
  ds_read_b64 v[120:121], v164 offset:3136
  v_mfma_f32_16x16x32_bf16 v[20:23], v[32:35], v[84:87], 0
  ds_read_b64 v[122:123], v164 offset:3144
  v_mfma_f32_16x16x32_bf16 v[20:23], v[36:39], v[80:83], v[20:23]
  ds_read_b128 v[156:159], v165 offset:3968
  v_mfma_f32_16x16x32_bf16 v[20:23], v[40:43], v[76:79], v[20:23]
  ds_read_b64 v[124:125], v164 offset:3648
  v_mfma_f32_16x16x32_bf16 v[20:23], v[44:47], v[72:75], v[20:23]
  ds_read_b64 v[126:127], v164 offset:3656
  v_mfma_f32_16x16x32_bf16 v[20:23], v[48:51], v[68:71], v[20:23]
  v_mfma_f32_16x16x32_bf16 v[20:23], v[52:55], v[64:67], v[20:23]
  v_mfma_f32_16x16x32_bf16 v[20:23], v[160:163], v[84:87], v[20:23]
  v_mfma_f32_16x16x32_bf16 v[24:27], v[32:35], v[88:91], 0
  v_mfma_f32_16x16x32_bf16 v[24:27], v[36:39], v[84:87], v[24:27]
  v_mfma_f32_16x16x32_bf16 v[24:27], v[40:43], v[80:83], v[24:27]
  v_mfma_f32_16x16x32_bf16 v[24:27], v[44:47], v[76:79], v[24:27]
  v_mfma_f32_16x16x32_bf16 v[24:27], v[48:51], v[72:75], v[24:27]
  v_mfma_f32_16x16x32_bf16 v[24:27], v[52:55], v[68:71], v[24:27]
  v_mfma_f32_16x16x32_bf16 v[24:27], v[56:59], v[64:67], v[24:27]
  v_mfma_f32_16x16x32_bf16 v[24:27], v[160:163], v[88:91], v[24:27]
  v_mfma_f32_16x16x32_bf16 v[28:31], v[32:35], v[92:95], 0
  v_mfma_f32_16x16x32_bf16 v[28:31], v[36:39], v[88:91], v[28:31]
  v_mfma_f32_16x16x32_bf16 v[28:31], v[40:43], v[84:87], v[28:31]
  v_mfma_f32_16x16x32_bf16 v[28:31], v[44:47], v[80:83], v[28:31]
  v_mfma_f32_16x16x32_bf16 v[28:31], v[48:51], v[76:79], v[28:31]
  v_mfma_f32_16x16x32_bf16 v[28:31], v[52:55], v[72:75], v[28:31]
  v_mfma_f32_16x16x32_bf16 v[28:31], v[56:59], v[68:71], v[28:31]
  v_mfma_f32_16x16x32_bf16 v[28:31], v[60:63], v[64:67], v[28:31]
  v_mfma_f32_16x16x32_bf16 v[28:31], v[160:163], v[92:95], v[28:31]
  s_waitcnt lgkmcnt(0)
  v_mfma_f32_16x16x32_bf16 v[0:3], v[96:99], v[128:131], v[0:3]
  ds_read_b128 v[64:67], v165 offset:320
  v_mfma_f32_16x16x32_bf16 v[4:7], v[96:99], v[132:135], v[4:7]
  ds_read_b64 v[32:33], v164 offset:128
  v_mfma_f32_16x16x32_bf16 v[4:7], v[100:103], v[128:131], v[4:7]
  ds_read_b64 v[34:35], v164 offset:136
  v_mfma_f32_16x16x32_bf16 v[8:11], v[96:99], v[136:139], v[8:11]
  ds_read_b128 v[68:71], v165 offset:832
  v_mfma_f32_16x16x32_bf16 v[8:11], v[100:103], v[132:135], v[8:11]
  ds_read_b64 v[36:37], v164 offset:640
  v_mfma_f32_16x16x32_bf16 v[8:11], v[104:107], v[128:131], v[8:11]
  ds_read_b64 v[38:39], v164 offset:648
  v_mfma_f32_16x16x32_bf16 v[12:15], v[96:99], v[140:143], v[12:15]
  ds_read_b128 v[72:75], v165 offset:1344
  v_mfma_f32_16x16x32_bf16 v[12:15], v[100:103], v[136:139], v[12:15]
  ds_read_b64 v[40:41], v164 offset:1152
  v_mfma_f32_16x16x32_bf16 v[12:15], v[104:107], v[132:135], v[12:15]
  ds_read_b64 v[42:43], v164 offset:1160
  v_mfma_f32_16x16x32_bf16 v[12:15], v[108:111], v[128:131], v[12:15]
  ds_read_b128 v[76:79], v165 offset:1856
  v_mfma_f32_16x16x32_bf16 v[16:19], v[96:99], v[144:147], v[16:19]
  ds_read_b64 v[44:45], v164 offset:1664
  v_mfma_f32_16x16x32_bf16 v[16:19], v[100:103], v[140:143], v[16:19]
  ds_read_b64 v[46:47], v164 offset:1672
  v_mfma_f32_16x16x32_bf16 v[16:19], v[104:107], v[136:139], v[16:19]
  ds_read_b128 v[80:83], v165 offset:2368
  v_mfma_f32_16x16x32_bf16 v[16:19], v[108:111], v[132:135], v[16:19]
  ds_read_b64 v[48:49], v164 offset:2176
  v_mfma_f32_16x16x32_bf16 v[16:19], v[112:115], v[128:131], v[16:19]
  ds_read_b64 v[50:51], v164 offset:2184
  v_mfma_f32_16x16x32_bf16 v[20:23], v[96:99], v[148:151], v[20:23]
  ds_read_b128 v[84:87], v165 offset:2880
  v_mfma_f32_16x16x32_bf16 v[20:23], v[100:103], v[144:147], v[20:23]
  ds_read_b64 v[52:53], v164 offset:2688
  v_mfma_f32_16x16x32_bf16 v[20:23], v[104:107], v[140:143], v[20:23]
  ds_read_b64 v[54:55], v164 offset:2696
  v_mfma_f32_16x16x32_bf16 v[20:23], v[108:111], v[136:139], v[20:23]
  ds_read_b128 v[88:91], v165 offset:3392
  v_mfma_f32_16x16x32_bf16 v[20:23], v[112:115], v[132:135], v[20:23]
  ds_read_b64 v[56:57], v164 offset:3200
  v_mfma_f32_16x16x32_bf16 v[20:23], v[116:119], v[128:131], v[20:23]
  ds_read_b64 v[58:59], v164 offset:3208
  v_mfma_f32_16x16x32_bf16 v[24:27], v[96:99], v[152:155], v[24:27]
  ds_read_b128 v[92:95], v165 offset:3904
  v_mfma_f32_16x16x32_bf16 v[24:27], v[100:103], v[148:151], v[24:27]
  ds_read_b64 v[60:61], v164 offset:3712
  v_mfma_f32_16x16x32_bf16 v[24:27], v[104:107], v[144:147], v[24:27]
  ds_read_b64 v[62:63], v164 offset:3720
  v_mfma_f32_16x16x32_bf16 v[24:27], v[108:111], v[140:143], v[24:27]
  v_mfma_f32_16x16x32_bf16 v[24:27], v[112:115], v[136:139], v[24:27]
  v_mfma_f32_16x16x32_bf16 v[24:27], v[116:119], v[132:135], v[24:27]
  v_mfma_f32_16x16x32_bf16 v[24:27], v[120:123], v[128:131], v[24:27]
  v_mfma_f32_16x16x32_bf16 v[28:31], v[96:99], v[156:159], v[28:31]
  v_mfma_f32_16x16x32_bf16 v[28:31], v[100:103], v[152:155], v[28:31]
  v_mfma_f32_16x16x32_bf16 v[28:31], v[104:107], v[148:151], v[28:31]
  v_mfma_f32_16x16x32_bf16 v[28:31], v[108:111], v[144:147], v[28:31]
  v_mfma_f32_16x16x32_bf16 v[28:31], v[112:115], v[140:143], v[28:31]
  v_mfma_f32_16x16x32_bf16 v[28:31], v[116:119], v[136:139], v[28:31]
  v_mfma_f32_16x16x32_bf16 v[28:31], v[120:123], v[132:135], v[28:31]
  v_mfma_f32_16x16x32_bf16 v[28:31], v[124:127], v[128:131], v[28:31]
  s_waitcnt lgkmcnt(0)
  v_mfma_f32_16x16x32_bf16 v[0:3], v[32:35], v[64:67], v[0:3]
  ds_read_b128 v[128:131], v165 offset:256
  v_mfma_f32_16x16x32_bf16 v[4:7], v[32:35], v[68:71], v[4:7]
  ds_read_b64 v[96:97], v164 offset:192
  v_mfma_f32_16x16x32_bf16 v[4:7], v[36:39], v[64:67], v[4:7]
  ds_read_b64 v[98:99], v164 offset:200
  v_mfma_f32_16x16x32_bf16 v[8:11], v[32:35], v[72:75], v[8:11]
  ds_read_b128 v[132:135], v165 offset:768
  v_mfma_f32_16x16x32_bf16 v[8:11], v[36:39], v[68:71], v[8:11]
  ds_read_b64 v[100:101], v164 offset:704
  v_mfma_f32_16x16x32_bf16 v[8:11], v[40:43], v[64:67], v[8:11]
  ds_read_b64 v[102:103], v164 offset:712
  v_mfma_f32_16x16x32_bf16 v[12:15], v[32:35], v[76:79], v[12:15]
  ds_read_b128 v[136:139], v165 offset:1280
  v_mfma_f32_16x16x32_bf16 v[12:15], v[36:39], v[72:75], v[12:15]
  ds_read_b64 v[104:105], v164 offset:1216
  v_mfma_f32_16x16x32_bf16 v[12:15], v[40:43], v[68:71], v[12:15]
  ds_read_b64 v[106:107], v164 offset:1224
  v_mfma_f32_16x16x32_bf16 v[12:15], v[44:47], v[64:67], v[12:15]
  ds_read_b128 v[140:143], v165 offset:1792
  v_mfma_f32_16x16x32_bf16 v[16:19], v[32:35], v[80:83], v[16:19]
  ds_read_b64 v[108:109], v164 offset:1728
  v_mfma_f32_16x16x32_bf16 v[16:19], v[36:39], v[76:79], v[16:19]
  ds_read_b64 v[110:111], v164 offset:1736
  v_mfma_f32_16x16x32_bf16 v[16:19], v[40:43], v[72:75], v[16:19]
  ds_read_b128 v[144:147], v165 offset:2304
  v_mfma_f32_16x16x32_bf16 v[16:19], v[44:47], v[68:71], v[16:19]
  ds_read_b64 v[112:113], v164 offset:2240
  v_mfma_f32_16x16x32_bf16 v[16:19], v[48:51], v[64:67], v[16:19]
  ds_read_b64 v[114:115], v164 offset:2248
  v_mfma_f32_16x16x32_bf16 v[20:23], v[32:35], v[84:87], v[20:23]
  ds_read_b128 v[148:151], v165 offset:2816
  v_mfma_f32_16x16x32_bf16 v[20:23], v[36:39], v[80:83], v[20:23]
  ds_read_b64 v[116:117], v164 offset:2752
  v_mfma_f32_16x16x32_bf16 v[20:23], v[40:43], v[76:79], v[20:23]
  ds_read_b64 v[118:119], v164 offset:2760
  v_mfma_f32_16x16x32_bf16 v[20:23], v[44:47], v[72:75], v[20:23]
  ds_read_b128 v[152:155], v165 offset:3328
  v_mfma_f32_16x16x32_bf16 v[20:23], v[48:51], v[68:71], v[20:23]
  ds_read_b64 v[120:121], v164 offset:3264
  v_mfma_f32_16x16x32_bf16 v[20:23], v[52:55], v[64:67], v[20:23]
  ds_read_b64 v[122:123], v164 offset:3272
  v_mfma_f32_16x16x32_bf16 v[24:27], v[32:35], v[88:91], v[24:27]
  ds_read_b128 v[156:159], v165 offset:3840
  v_mfma_f32_16x16x32_bf16 v[24:27], v[36:39], v[84:87], v[24:27]
  ds_read_b64 v[124:125], v164 offset:3776
  v_mfma_f32_16x16x32_bf16 v[24:27], v[40:43], v[80:83], v[24:27]
  ds_read_b64 v[126:127], v164 offset:3784
  v_mfma_f32_16x16x32_bf16 v[24:27], v[44:47], v[76:79], v[24:27]
  v_mfma_f32_16x16x32_bf16 v[24:27], v[48:51], v[72:75], v[24:27]
  v_mfma_f32_16x16x32_bf16 v[24:27], v[52:55], v[68:71], v[24:27]
  v_mfma_f32_16x16x32_bf16 v[24:27], v[56:59], v[64:67], v[24:27]
  v_mfma_f32_16x16x32_bf16 v[28:31], v[32:35], v[92:95], v[28:31]
  v_mfma_f32_16x16x32_bf16 v[28:31], v[36:39], v[88:91], v[28:31]
  v_mfma_f32_16x16x32_bf16 v[28:31], v[40:43], v[84:87], v[28:31]
  v_mfma_f32_16x16x32_bf16 v[28:31], v[44:47], v[80:83], v[28:31]
  v_mfma_f32_16x16x32_bf16 v[28:31], v[48:51], v[76:79], v[28:31]
  v_mfma_f32_16x16x32_bf16 v[28:31], v[52:55], v[72:75], v[28:31]
  v_mfma_f32_16x16x32_bf16 v[28:31], v[56:59], v[68:71], v[28:31]
  v_mfma_f32_16x16x32_bf16 v[28:31], v[60:63], v[64:67], v[28:31]
  s_waitcnt lgkmcnt(0)
  v_mov_b32 v168, 1
  v_mov_b32 v169, 163072
  s_waitcnt vmcnt(0)
  s_mov_b64 exec, 1
  ds_add_u32 v169, v168 offset:44
  s_mov_b64 exec, -1
  v_mfma_f32_16x16x32_bf16 v[0:3], v[96:99], v[128:131], v[0:3]
  ds_read_b128 v[64:67], v165 offset:192
  v_mfma_f32_16x16x32_bf16 v[4:7], v[96:99], v[132:135], v[4:7]
  ds_read_b64 v[32:33], v164 offset:256
  v_mfma_f32_16x16x32_bf16 v[4:7], v[100:103], v[128:131], v[4:7]
  ds_read_b64 v[34:35], v164 offset:264
  v_mfma_f32_16x16x32_bf16 v[8:11], v[96:99], v[136:139], v[8:11]
  ds_read_b128 v[68:71], v165 offset:704
  v_mfma_f32_16x16x32_bf16 v[8:11], v[100:103], v[132:135], v[8:11]
  ds_read_b64 v[36:37], v164 offset:768
  v_mfma_f32_16x16x32_bf16 v[8:11], v[104:107], v[128:131], v[8:11]
  ds_read_b64 v[38:39], v164 offset:776
  v_mfma_f32_16x16x32_bf16 v[12:15], v[96:99], v[140:143], v[12:15]
  ds_read_b128 v[72:75], v165 offset:1216
  v_mfma_f32_16x16x32_bf16 v[12:15], v[100:103], v[136:139], v[12:15]
  ds_read_b64 v[40:41], v164 offset:1280
  v_mfma_f32_16x16x32_bf16 v[12:15], v[104:107], v[132:135], v[12:15]
  ds_read_b64 v[42:43], v164 offset:1288
  v_mfma_f32_16x16x32_bf16 v[12:15], v[108:111], v[128:131], v[12:15]
  ds_read_b128 v[76:79], v165 offset:1728
  v_mfma_f32_16x16x32_bf16 v[16:19], v[96:99], v[144:147], v[16:19]
  ds_read_b64 v[44:45], v164 offset:1792
  v_mfma_f32_16x16x32_bf16 v[16:19], v[100:103], v[140:143], v[16:19]
  ds_read_b64 v[46:47], v164 offset:1800
  v_mfma_f32_16x16x32_bf16 v[16:19], v[104:107], v[136:139], v[16:19]
  ds_read_b128 v[80:83], v165 offset:2240
  v_mfma_f32_16x16x32_bf16 v[16:19], v[108:111], v[132:135], v[16:19]
  ds_read_b64 v[48:49], v164 offset:2304
  v_mfma_f32_16x16x32_bf16 v[16:19], v[112:115], v[128:131], v[16:19]
  ds_read_b64 v[50:51], v164 offset:2312
  v_mfma_f32_16x16x32_bf16 v[20:23], v[96:99], v[148:151], v[20:23]
  ds_read_b128 v[84:87], v165 offset:2752
  v_mfma_f32_16x16x32_bf16 v[20:23], v[100:103], v[144:147], v[20:23]
  ds_read_b64 v[52:53], v164 offset:2816
  v_mfma_f32_16x16x32_bf16 v[20:23], v[104:107], v[140:143], v[20:23]
  ds_read_b64 v[54:55], v164 offset:2824
  v_mfma_f32_16x16x32_bf16 v[20:23], v[108:111], v[136:139], v[20:23]
  ds_read_b128 v[88:91], v165 offset:3264
  v_mfma_f32_16x16x32_bf16 v[20:23], v[112:115], v[132:135], v[20:23]
  ds_read_b64 v[56:57], v164 offset:3328
  v_mfma_f32_16x16x32_bf16 v[20:23], v[116:119], v[128:131], v[20:23]
  ds_read_b64 v[58:59], v164 offset:3336
  v_mfma_f32_16x16x32_bf16 v[24:27], v[96:99], v[152:155], v[24:27]
  ds_read_b128 v[92:95], v165 offset:3776
  v_mfma_f32_16x16x32_bf16 v[24:27], v[100:103], v[148:151], v[24:27]
  ds_read_b64 v[60:61], v164 offset:3840
  v_mfma_f32_16x16x32_bf16 v[24:27], v[104:107], v[144:147], v[24:27]
  ds_read_b64 v[62:63], v164 offset:3848
  v_mfma_f32_16x16x32_bf16 v[24:27], v[108:111], v[140:143], v[24:27]
  v_mfma_f32_16x16x32_bf16 v[24:27], v[112:115], v[136:139], v[24:27]
  v_mfma_f32_16x16x32_bf16 v[24:27], v[116:119], v[132:135], v[24:27]
  v_mfma_f32_16x16x32_bf16 v[24:27], v[120:123], v[128:131], v[24:27]
  v_mfma_f32_16x16x32_bf16 v[28:31], v[96:99], v[156:159], v[28:31]
  v_mfma_f32_16x16x32_bf16 v[28:31], v[100:103], v[152:155], v[28:31]
  v_mfma_f32_16x16x32_bf16 v[28:31], v[104:107], v[148:151], v[28:31]
  v_mfma_f32_16x16x32_bf16 v[28:31], v[108:111], v[144:147], v[28:31]
  v_mfma_f32_16x16x32_bf16 v[28:31], v[112:115], v[140:143], v[28:31]
  v_mfma_f32_16x16x32_bf16 v[28:31], v[116:119], v[136:139], v[28:31]
  v_mfma_f32_16x16x32_bf16 v[28:31], v[120:123], v[132:135], v[28:31]
  v_mfma_f32_16x16x32_bf16 v[28:31], v[124:127], v[128:131], v[28:31]
  s_waitcnt lgkmcnt(0)
  v_mfma_f32_16x16x32_bf16 v[0:3], v[32:35], v[64:67], v[0:3]
  ds_read_b128 v[128:131], v165 offset:128
  v_mfma_f32_16x16x32_bf16 v[4:7], v[32:35], v[68:71], v[4:7]
  ds_read_b64 v[96:97], v164 offset:320
  v_mfma_f32_16x16x32_bf16 v[4:7], v[36:39], v[64:67], v[4:7]
  ds_read_b64 v[98:99], v164 offset:328
  v_mfma_f32_16x16x32_bf16 v[8:11], v[32:35], v[72:75], v[8:11]
  ds_read_b128 v[132:135], v165 offset:640
  v_mfma_f32_16x16x32_bf16 v[8:11], v[36:39], v[68:71], v[8:11]
  ds_read_b64 v[100:101], v164 offset:832
  v_mfma_f32_16x16x32_bf16 v[8:11], v[40:43], v[64:67], v[8:11]
  ds_read_b64 v[102:103], v164 offset:840
  v_mfma_f32_16x16x32_bf16 v[12:15], v[32:35], v[76:79], v[12:15]
  ds_read_b128 v[136:139], v165 offset:1152
  v_mfma_f32_16x16x32_bf16 v[12:15], v[36:39], v[72:75], v[12:15]
  ds_read_b64 v[104:105], v164 offset:1344
  v_mfma_f32_16x16x32_bf16 v[12:15], v[40:43], v[68:71], v[12:15]
  ds_read_b64 v[106:107], v164 offset:1352
  v_mfma_f32_16x16x32_bf16 v[12:15], v[44:47], v[64:67], v[12:15]
  ds_read_b128 v[140:143], v165 offset:1664
  v_mfma_f32_16x16x32_bf16 v[16:19], v[32:35], v[80:83], v[16:19]
  ds_read_b64 v[108:109], v164 offset:1856
  v_mfma_f32_16x16x32_bf16 v[16:19], v[36:39], v[76:79], v[16:19]
  ds_read_b64 v[110:111], v164 offset:1864
  v_mfma_f32_16x16x32_bf16 v[16:19], v[40:43], v[72:75], v[16:19]
  ds_read_b128 v[144:147], v165 offset:2176
  v_mfma_f32_16x16x32_bf16 v[16:19], v[44:47], v[68:71], v[16:19]
  ds_read_b64 v[112:113], v164 offset:2368
  v_mfma_f32_16x16x32_bf16 v[16:19], v[48:51], v[64:67], v[16:19]
  ds_read_b64 v[114:115], v164 offset:2376
  v_mfma_f32_16x16x32_bf16 v[20:23], v[32:35], v[84:87], v[20:23]
  ds_read_b128 v[148:151], v165 offset:2688
  v_mfma_f32_16x16x32_bf16 v[20:23], v[36:39], v[80:83], v[20:23]
  ds_read_b64 v[116:117], v164 offset:2880
  v_mfma_f32_16x16x32_bf16 v[20:23], v[40:43], v[76:79], v[20:23]
  ds_read_b64 v[118:119], v164 offset:2888
  v_mfma_f32_16x16x32_bf16 v[20:23], v[44:47], v[72:75], v[20:23]
  ds_read_b128 v[152:155], v165 offset:3200
  v_mfma_f32_16x16x32_bf16 v[20:23], v[48:51], v[68:71], v[20:23]
  ds_read_b64 v[120:121], v164 offset:3392
  v_mfma_f32_16x16x32_bf16 v[20:23], v[52:55], v[64:67], v[20:23]
  ds_read_b64 v[122:123], v164 offset:3400
  v_mfma_f32_16x16x32_bf16 v[24:27], v[32:35], v[88:91], v[24:27]
  ds_read_b128 v[156:159], v165 offset:3712
  v_mfma_f32_16x16x32_bf16 v[24:27], v[36:39], v[84:87], v[24:27]
  ds_read_b64 v[124:125], v164 offset:3904
  v_mfma_f32_16x16x32_bf16 v[24:27], v[40:43], v[80:83], v[24:27]
  ds_read_b64 v[126:127], v164 offset:3912
  v_mfma_f32_16x16x32_bf16 v[24:27], v[44:47], v[76:79], v[24:27]
  v_mfma_f32_16x16x32_bf16 v[24:27], v[48:51], v[72:75], v[24:27]
  v_mfma_f32_16x16x32_bf16 v[24:27], v[52:55], v[68:71], v[24:27]
  v_mfma_f32_16x16x32_bf16 v[24:27], v[56:59], v[64:67], v[24:27]
  v_mfma_f32_16x16x32_bf16 v[28:31], v[32:35], v[92:95], v[28:31]
  v_mfma_f32_16x16x32_bf16 v[28:31], v[36:39], v[88:91], v[28:31]
  v_mfma_f32_16x16x32_bf16 v[28:31], v[40:43], v[84:87], v[28:31]
  v_mfma_f32_16x16x32_bf16 v[28:31], v[44:47], v[80:83], v[28:31]
  v_mfma_f32_16x16x32_bf16 v[28:31], v[48:51], v[76:79], v[28:31]
  v_mfma_f32_16x16x32_bf16 v[28:31], v[52:55], v[72:75], v[28:31]
  v_mfma_f32_16x16x32_bf16 v[28:31], v[56:59], v[68:71], v[28:31]
  v_mfma_f32_16x16x32_bf16 v[28:31], v[60:63], v[64:67], v[28:31]
  s_waitcnt lgkmcnt(0)
  v_mfma_f32_16x16x32_bf16 v[0:3], v[96:99], v[128:131], v[0:3]
  ds_read_b128 v[64:67], v165 offset:64
  v_mfma_f32_16x16x32_bf16 v[4:7], v[96:99], v[132:135], v[4:7]
  ds_read_b64 v[32:33], v164 offset:384
  v_mfma_f32_16x16x32_bf16 v[4:7], v[100:103], v[128:131], v[4:7]
  ds_read_b64 v[34:35], v164 offset:392
  v_mfma_f32_16x16x32_bf16 v[8:11], v[96:99], v[136:139], v[8:11]
  ds_read_b128 v[68:71], v165 offset:576
  v_mfma_f32_16x16x32_bf16 v[8:11], v[100:103], v[132:135], v[8:11]
  ds_read_b64 v[36:37], v164 offset:896
  v_mfma_f32_16x16x32_bf16 v[8:11], v[104:107], v[128:131], v[8:11]
  ds_read_b64 v[38:39], v164 offset:904
  v_mfma_f32_16x16x32_bf16 v[12:15], v[96:99], v[140:143], v[12:15]
  ds_read_b128 v[72:75], v165 offset:1088
  v_mfma_f32_16x16x32_bf16 v[12:15], v[100:103], v[136:139], v[12:15]
  ds_read_b64 v[40:41], v164 offset:1408
  v_mfma_f32_16x16x32_bf16 v[12:15], v[104:107], v[132:135], v[12:15]
  ds_read_b64 v[42:43], v164 offset:1416
  v_mfma_f32_16x16x32_bf16 v[12:15], v[108:111], v[128:131], v[12:15]
  ds_read_b128 v[76:79], v165 offset:1600
  v_mfma_f32_16x16x32_bf16 v[16:19], v[96:99], v[144:147], v[16:19]
  ds_read_b64 v[44:45], v164 offset:1920
  v_mfma_f32_16x16x32_bf16 v[16:19], v[100:103], v[140:143], v[16:19]
  ds_read_b64 v[46:47], v164 offset:1928
  v_mfma_f32_16x16x32_bf16 v[16:19], v[104:107], v[136:139], v[16:19]
  ds_read_b128 v[80:83], v165 offset:2112
  v_mfma_f32_16x16x32_bf16 v[16:19], v[108:111], v[132:135], v[16:19]
  ds_read_b64 v[48:49], v164 offset:2432
  v_mfma_f32_16x16x32_bf16 v[16:19], v[112:115], v[128:131], v[16:19]
  ds_read_b64 v[50:51], v164 offset:2440
  v_mfma_f32_16x16x32_bf16 v[20:23], v[96:99], v[148:151], v[20:23]
  ds_read_b128 v[84:87], v165 offset:2624
  v_mfma_f32_16x16x32_bf16 v[20:23], v[100:103], v[144:147], v[20:23]
  ds_read_b64 v[52:53], v164 offset:2944
  v_mfma_f32_16x16x32_bf16 v[20:23], v[104:107], v[140:143], v[20:23]
  ds_read_b64 v[54:55], v164 offset:2952
  v_mfma_f32_16x16x32_bf16 v[20:23], v[108:111], v[136:139], v[20:23]
  ds_read_b128 v[88:91], v165 offset:3136
  v_mfma_f32_16x16x32_bf16 v[20:23], v[112:115], v[132:135], v[20:23]
  ds_read_b64 v[56:57], v164 offset:3456
  v_mfma_f32_16x16x32_bf16 v[20:23], v[116:119], v[128:131], v[20:23]
  ds_read_b64 v[58:59], v164 offset:3464
  v_mfma_f32_16x16x32_bf16 v[24:27], v[96:99], v[152:155], v[24:27]
  ds_read_b128 v[92:95], v165 offset:3648
  v_mfma_f32_16x16x32_bf16 v[24:27], v[100:103], v[148:151], v[24:27]
  ds_read_b64 v[60:61], v164 offset:3968
  v_mfma_f32_16x16x32_bf16 v[24:27], v[104:107], v[144:147], v[24:27]
  ds_read_b64 v[62:63], v164 offset:3976
  v_mfma_f32_16x16x32_bf16 v[24:27], v[108:111], v[140:143], v[24:27]
  v_mfma_f32_16x16x32_bf16 v[24:27], v[112:115], v[136:139], v[24:27]
  v_mfma_f32_16x16x32_bf16 v[24:27], v[116:119], v[132:135], v[24:27]
  v_mfma_f32_16x16x32_bf16 v[24:27], v[120:123], v[128:131], v[24:27]
  v_mfma_f32_16x16x32_bf16 v[28:31], v[96:99], v[156:159], v[28:31]
  v_mfma_f32_16x16x32_bf16 v[28:31], v[100:103], v[152:155], v[28:31]
  v_mfma_f32_16x16x32_bf16 v[28:31], v[104:107], v[148:151], v[28:31]
  v_mfma_f32_16x16x32_bf16 v[28:31], v[108:111], v[144:147], v[28:31]
  v_mfma_f32_16x16x32_bf16 v[28:31], v[112:115], v[140:143], v[28:31]
  v_mfma_f32_16x16x32_bf16 v[28:31], v[116:119], v[136:139], v[28:31]
  v_mfma_f32_16x16x32_bf16 v[28:31], v[120:123], v[132:135], v[28:31]
  v_mfma_f32_16x16x32_bf16 v[28:31], v[124:127], v[128:131], v[28:31]
  s_waitcnt lgkmcnt(0)
  v_mfma_f32_16x16x32_bf16 v[0:3], v[32:35], v[64:67], v[0:3]
  ds_read_b128 v[128:131], v165 offset:0
  v_mfma_f32_16x16x32_bf16 v[4:7], v[32:35], v[68:71], v[4:7]
  ds_read_b64 v[96:97], v164 offset:448
  v_mfma_f32_16x16x32_bf16 v[4:7], v[36:39], v[64:67], v[4:7]
  ds_read_b64 v[98:99], v164 offset:456
  v_mfma_f32_16x16x32_bf16 v[8:11], v[32:35], v[72:75], v[8:11]
  ds_read_b128 v[132:135], v165 offset:512
  v_mfma_f32_16x16x32_bf16 v[8:11], v[36:39], v[68:71], v[8:11]
  ds_read_b64 v[100:101], v164 offset:960
  v_mfma_f32_16x16x32_bf16 v[8:11], v[40:43], v[64:67], v[8:11]
  ds_read_b64 v[102:103], v164 offset:968
  v_mfma_f32_16x16x32_bf16 v[12:15], v[32:35], v[76:79], v[12:15]
  ds_read_b128 v[136:139], v165 offset:1024
  v_mfma_f32_16x16x32_bf16 v[12:15], v[36:39], v[72:75], v[12:15]
  ds_read_b64 v[104:105], v164 offset:1472
  v_mfma_f32_16x16x32_bf16 v[12:15], v[40:43], v[68:71], v[12:15]
  ds_read_b64 v[106:107], v164 offset:1480
  v_mfma_f32_16x16x32_bf16 v[12:15], v[44:47], v[64:67], v[12:15]
  ds_read_b128 v[140:143], v165 offset:1536
  v_mfma_f32_16x16x32_bf16 v[16:19], v[32:35], v[80:83], v[16:19]
  ds_read_b64 v[108:109], v164 offset:1984
  v_mfma_f32_16x16x32_bf16 v[16:19], v[36:39], v[76:79], v[16:19]
  ds_read_b64 v[110:111], v164 offset:1992
  v_mfma_f32_16x16x32_bf16 v[16:19], v[40:43], v[72:75], v[16:19]
  ds_read_b128 v[144:147], v165 offset:2048
  v_mfma_f32_16x16x32_bf16 v[16:19], v[44:47], v[68:71], v[16:19]
  ds_read_b64 v[112:113], v164 offset:2496
  v_mfma_f32_16x16x32_bf16 v[16:19], v[48:51], v[64:67], v[16:19]
  ds_read_b64 v[114:115], v164 offset:2504
  v_mfma_f32_16x16x32_bf16 v[20:23], v[32:35], v[84:87], v[20:23]
  ds_read_b128 v[148:151], v165 offset:2560
  v_mfma_f32_16x16x32_bf16 v[20:23], v[36:39], v[80:83], v[20:23]
  ds_read_b64 v[116:117], v164 offset:3008
  v_mfma_f32_16x16x32_bf16 v[20:23], v[40:43], v[76:79], v[20:23]
  ds_read_b64 v[118:119], v164 offset:3016
  v_mfma_f32_16x16x32_bf16 v[20:23], v[44:47], v[72:75], v[20:23]
  ds_read_b128 v[152:155], v165 offset:3072
  v_mfma_f32_16x16x32_bf16 v[20:23], v[48:51], v[68:71], v[20:23]
  ds_read_b64 v[120:121], v164 offset:3520
  v_mfma_f32_16x16x32_bf16 v[20:23], v[52:55], v[64:67], v[20:23]
  ds_read_b64 v[122:123], v164 offset:3528
  v_mfma_f32_16x16x32_bf16 v[24:27], v[32:35], v[88:91], v[24:27]
  ds_read_b128 v[156:159], v165 offset:3584
  v_mfma_f32_16x16x32_bf16 v[24:27], v[36:39], v[84:87], v[24:27]
  ds_read_b64 v[124:125], v164 offset:4032
  v_mfma_f32_16x16x32_bf16 v[24:27], v[40:43], v[80:83], v[24:27]
  ds_read_b64 v[126:127], v164 offset:4040
  v_mfma_f32_16x16x32_bf16 v[24:27], v[44:47], v[76:79], v[24:27]
  v_mfma_f32_16x16x32_bf16 v[24:27], v[48:51], v[72:75], v[24:27]
  v_mfma_f32_16x16x32_bf16 v[24:27], v[52:55], v[68:71], v[24:27]
  v_mfma_f32_16x16x32_bf16 v[24:27], v[56:59], v[64:67], v[24:27]
  v_mfma_f32_16x16x32_bf16 v[28:31], v[32:35], v[92:95], v[28:31]
  v_mfma_f32_16x16x32_bf16 v[28:31], v[36:39], v[88:91], v[28:31]
  v_mfma_f32_16x16x32_bf16 v[28:31], v[40:43], v[84:87], v[28:31]
  v_mfma_f32_16x16x32_bf16 v[28:31], v[44:47], v[80:83], v[28:31]
  v_mfma_f32_16x16x32_bf16 v[28:31], v[48:51], v[76:79], v[28:31]
  v_mfma_f32_16x16x32_bf16 v[28:31], v[52:55], v[72:75], v[28:31]
  v_mfma_f32_16x16x32_bf16 v[28:31], v[56:59], v[68:71], v[28:31]
  v_mfma_f32_16x16x32_bf16 v[28:31], v[60:63], v[64:67], v[28:31]
  s_waitcnt lgkmcnt(0)
  v_mfma_f32_16x16x32_bf16 v[0:3], v[96:99], v[128:131], v[0:3]
  v_mfma_f32_16x16x32_bf16 v[4:7], v[96:99], v[132:135], v[4:7]
  v_mfma_f32_16x16x32_bf16 v[4:7], v[100:103], v[128:131], v[4:7]
  v_mfma_f32_16x16x32_bf16 v[8:11], v[96:99], v[136:139], v[8:11]
  v_mfma_f32_16x16x32_bf16 v[8:11], v[100:103], v[132:135], v[8:11]
  v_mfma_f32_16x16x32_bf16 v[8:11], v[104:107], v[128:131], v[8:11]
  v_mfma_f32_16x16x32_bf16 v[12:15], v[96:99], v[140:143], v[12:15]
  v_mfma_f32_16x16x32_bf16 v[12:15], v[100:103], v[136:139], v[12:15]
  v_mfma_f32_16x16x32_bf16 v[12:15], v[104:107], v[132:135], v[12:15]
  v_mfma_f32_16x16x32_bf16 v[12:15], v[108:111], v[128:131], v[12:15]
  v_mfma_f32_16x16x32_bf16 v[16:19], v[96:99], v[144:147], v[16:19]
  v_mfma_f32_16x16x32_bf16 v[16:19], v[100:103], v[140:143], v[16:19]
  v_mfma_f32_16x16x32_bf16 v[16:19], v[104:107], v[136:139], v[16:19]
  v_mfma_f32_16x16x32_bf16 v[16:19], v[108:111], v[132:135], v[16:19]
  v_mfma_f32_16x16x32_bf16 v[16:19], v[112:115], v[128:131], v[16:19]
  v_mfma_f32_16x16x32_bf16 v[20:23], v[96:99], v[148:151], v[20:23]
  v_mfma_f32_16x16x32_bf16 v[20:23], v[100:103], v[144:147], v[20:23]
  v_mfma_f32_16x16x32_bf16 v[20:23], v[104:107], v[140:143], v[20:23]
  v_mfma_f32_16x16x32_bf16 v[20:23], v[108:111], v[136:139], v[20:23]
  v_mfma_f32_16x16x32_bf16 v[20:23], v[112:115], v[132:135], v[20:23]
  v_mfma_f32_16x16x32_bf16 v[20:23], v[116:119], v[128:131], v[20:23]
  v_mfma_f32_16x16x32_bf16 v[24:27], v[96:99], v[152:155], v[24:27]
  v_mfma_f32_16x16x32_bf16 v[24:27], v[100:103], v[148:151], v[24:27]
  v_mfma_f32_16x16x32_bf16 v[24:27], v[104:107], v[144:147], v[24:27]
  v_mfma_f32_16x16x32_bf16 v[24:27], v[108:111], v[140:143], v[24:27]
  v_mfma_f32_16x16x32_bf16 v[24:27], v[112:115], v[136:139], v[24:27]
  v_mfma_f32_16x16x32_bf16 v[24:27], v[116:119], v[132:135], v[24:27]
  v_mfma_f32_16x16x32_bf16 v[24:27], v[120:123], v[128:131], v[24:27]
  v_mfma_f32_16x16x32_bf16 v[28:31], v[96:99], v[156:159], v[28:31]
  v_mfma_f32_16x16x32_bf16 v[28:31], v[100:103], v[152:155], v[28:31]
  v_mfma_f32_16x16x32_bf16 v[28:31], v[104:107], v[148:151], v[28:31]
  v_mfma_f32_16x16x32_bf16 v[28:31], v[108:111], v[144:147], v[28:31]
  v_mfma_f32_16x16x32_bf16 v[28:31], v[112:115], v[140:143], v[28:31]
  v_mfma_f32_16x16x32_bf16 v[28:31], v[116:119], v[136:139], v[28:31]
  v_mfma_f32_16x16x32_bf16 v[28:31], v[120:123], v[132:135], v[28:31]
  v_mfma_f32_16x16x32_bf16 v[28:31], v[124:127], v[128:131], v[28:31]
  s_nop 7
  s_add_u32 s75, s82, 0x800000
  v_cvt_pk_bf16_f32 v32, v0, v1
  v_cvt_pk_bf16_f32 v33, v2, v3
  v_cvt_pk_bf16_f32 v34, v4, v5
  v_cvt_pk_bf16_f32 v35, v6, v7
  v_cvt_pk_bf16_f32 v36, v8, v9
  v_cvt_pk_bf16_f32 v37, v10, v11
  v_cvt_pk_bf16_f32 v38, v12, v13
  v_cvt_pk_bf16_f32 v39, v14, v15
  v_cvt_pk_bf16_f32 v40, v16, v17
  v_cvt_pk_bf16_f32 v41, v18, v19
  v_cvt_pk_bf16_f32 v42, v20, v21
  v_cvt_pk_bf16_f32 v43, v22, v23
  v_cvt_pk_bf16_f32 v44, v24, v25
  v_cvt_pk_bf16_f32 v45, v26, v27
  v_cvt_pk_bf16_f32 v46, v28, v29
  v_cvt_pk_bf16_f32 v47, v30, v31
  buffer_store_dwordx2 v[32:33], v166, s[44:47], s75 offen offset:0 sc1
  buffer_store_dwordx2 v[34:35], v166, s[44:47], s75 offen offset:512 sc1
  buffer_store_dwordx2 v[36:37], v166, s[44:47], s75 offen offset:1024 sc1
  buffer_store_dwordx2 v[38:39], v166, s[44:47], s75 offen offset:1536 sc1
  buffer_store_dwordx2 v[40:41], v166, s[44:47], s75 offen offset:2048 sc1
  buffer_store_dwordx2 v[42:43], v166, s[44:47], s75 offen offset:2560 sc1
  buffer_store_dwordx2 v[44:45], v166, s[44:47], s75 offen offset:3072 sc1
  buffer_store_dwordx2 v[46:47], v166, s[44:47], s75 offen offset:3584 sc1
  v_mov_b32 v2, 163072
  v_mov_b32 v3, 1
  s_mov_b64 exec, 1
  ds_add_u32 v2, v3 offset:24
  s_mov_b64 exec, -1
  s_lshr_b32 s76, s2, 4
  s_and_b32 s77, s2, 15
  s_lshl_b32 s80, s76, 4
  s_add_u32 s80, s80, s77
  s_lshl_b32 s80, s80, 8
  s_add_u32 s80, s80, 0xf30000
  s_lshl_b32 s81, s71, 2
  v_mov_b32 v4, s68
  v_mov_b32 v5, s81
  s_waitcnt vmcnt(0)
  s_mov_b64 exec, 1
  buffer_store_dword v4, v5, s[44:47], s80 offen sc1
  s_mov_b64 exec, -1
  s_mov_b32 s77, 0
L_lp_8:
  ds_read_b32 v4, v2 offset:24
  s_waitcnt lgkmcnt(0)
  v_readfirstlane_b32 s76, v4
  s_add_u32 s77, s77, 1
  s_cmp_ge_u32 s76, 4
  s_cbranch_scc1 L_lpd_9
  s_cmp_lt_u32 s77, 3200000
  s_cbranch_scc1 L_lp_8
L_lpd_9:
  s_lshl_b32 s74, s12, 6
  s_add_u32 m0, s73, 0
  s_add_u32 s74, s74, s72
  buffer_load_dwordx4 v167, s[48:51], s74 offen  lds
  s_add_u32 m0, s73, 1024
  s_add_u32 s75, s74, 16384
  buffer_load_dwordx4 v167, s[48:51], s75 offen  lds
  s_lshl_b32 s74, s13, 6
  s_add_u32 m0, s73, 8192
  s_add_u32 s74, s74, s72
  buffer_load_dwordx4 v167, s[48:51], s74 offen  lds
  s_add_u32 m0, s73, 9216
  s_add_u32 s75, s74, 16384
  buffer_load_dwordx4 v167, s[48:51], s75 offen  lds
  s_lshl_b32 s74, s14, 6
  s_add_u32 m0, s73, 16384
  s_add_u32 s74, s74, s72
  buffer_load_dwordx4 v167, s[48:51], s74 offen  lds
  s_add_u32 m0, s73, 17408
  s_add_u32 s75, s74, 16384
  buffer_load_dwordx4 v167, s[48:51], s75 offen  lds
  s_lshl_b32 s74, s15, 6
  s_add_u32 m0, s73, 24576
  s_add_u32 s74, s74, s72
  buffer_load_dwordx4 v167, s[48:51], s74 offen  lds
  s_add_u32 m0, s73, 25600
  s_add_u32 s75, s74, 16384
  buffer_load_dwordx4 v167, s[48:51], s75 offen  lds
  s_lshl_b32 s74, s56, 6
  s_add_u32 m0, s73, 32768
  s_add_u32 s74, s74, s72
  buffer_load_dwordx4 v167, s[48:51], s74 offen  lds
  s_add_u32 m0, s73, 33792
  s_add_u32 s75, s74, 16384
  buffer_load_dwordx4 v167, s[48:51], s75 offen  lds
  s_lshl_b32 s74, s57, 6
  s_add_u32 m0, s73, 40960
  s_add_u32 s74, s74, s72
  buffer_load_dwordx4 v167, s[48:51], s74 offen  lds
  s_add_u32 m0, s73, 41984
  s_add_u32 s75, s74, 16384
  buffer_load_dwordx4 v167, s[48:51], s75 offen  lds
  s_lshl_b32 s74, s58, 6
  s_add_u32 m0, s73, 49152
  s_add_u32 s74, s74, s72
  buffer_load_dwordx4 v167, s[48:51], s74 offen  lds
  s_add_u32 m0, s73, 50176
  s_add_u32 s75, s74, 16384
  buffer_load_dwordx4 v167, s[48:51], s75 offen  lds
  s_lshl_b32 s74, s59, 6
  s_add_u32 m0, s73, 57344
  s_add_u32 s74, s74, s72
  buffer_load_dwordx4 v167, s[48:51], s74 offen  lds
  s_add_u32 m0, s73, 58368
  s_add_u32 s75, s74, 16384
  buffer_load_dwordx4 v167, s[48:51], s75 offen  lds
  s_waitcnt vmcnt(0)
  v_mov_b32 v3, 1
  s_mov_b64 exec, 1
  ds_add_u32 v2, v3 offset:48
  s_mov_b64 exec, -1
  s_cmp_ge_u32 s71, 2
  s_cbranch_scc1 L_yload
  s_endpgm
L_yload:
  v_lshrrev_b32 v8, 2, v250
  v_lshlrev_b32 v8, 8, v8
  v_and_b32 v9, 3, v250
  v_lshlrev_b32 v9, 2, v9
  v_add_u32 v8, v8, v9
  s_lshl_b32 s80, s70, 12
  s_add_u32 s80, s80, 0xf30000
  s_mov_b32 s72, 0xffffffff
  s_mov_b32 s73, 0xffffffff
  s_mov_b32 s74, 0
L_poll_10:
  buffer_load_dword v10, v8, s[44:47], s80 offen sc1
  s_waitcnt vmcnt(0)
  v_cmp_eq_u32 vcc, s68, v10
  s_add_u32 s74, s74, 1
  s_and_b64 vcc, vcc, s[72:73]
  s_cmp_eq_u64 vcc, s[72:73]
  s_cbranch_scc1 L_pdone_11
  s_cmp_lt_u32 s74, 200000
  s_cbranch_scc1 L_poll_10
L_pdone_11:
  s_sub_u32 s71, s71, 2
  v_lshrrev_b32 v4, 4, v250
  v_and_b32 v5, 15, v250
  v_lshlrev_b32 v6, 12, v4
  v_lshlrev_b32 v5, 4, v5
  v_add_u32 v6, v6, v5
  v_lshlrev_b32 v7, 8, v4
  v_add_u32 v7, v7, v5
  s_lshl_b32 s72, s70, 18
  s_lshl_b32 s73, s69, 8
  s_add_u32 s72, s72, s73
  s_lshl_b32 s73, s71, 17
  s_add_u32 s72, s72, s73
  s_add_u32 s72, s72, 0x800000
  s_lshl_b32 s73, s71, 13
  s_add_u32 s73, s73, 132096
  v_add_u32 v7, s73, v7
  s_add_u32 s74, s72, 0
  buffer_load_dwordx4 v[16:19], v6, s[44:47], s74 offen sc1
  s_add_u32 s74, s72, 16384
  buffer_load_dwordx4 v[20:23], v6, s[44:47], s74 offen sc1
  s_add_u32 s74, s72, 32768
  buffer_load_dwordx4 v[24:27], v6, s[44:47], s74 offen sc1
  s_add_u32 s74, s72, 49152
  buffer_load_dwordx4 v[28:31], v6, s[44:47], s74 offen sc1
  s_add_u32 s74, s72, 65536
  buffer_load_dwordx4 v[32:35], v6, s[44:47], s74 offen sc1
  s_add_u32 s74, s72, 81920
  buffer_load_dwordx4 v[36:39], v6, s[44:47], s74 offen sc1
  s_add_u32 s74, s72, 98304
  buffer_load_dwordx4 v[40:43], v6, s[44:47], s74 offen sc1
  s_add_u32 s74, s72, 114688
  buffer_load_dwordx4 v[44:47], v6, s[44:47], s74 offen sc1
  s_waitcnt vmcnt(0)
  ds_write_b128 v7, v[16:19] offset:0
  ds_write_b128 v7, v[20:23] offset:1024
  ds_write_b128 v7, v[24:27] offset:2048
  ds_write_b128 v7, v[28:31] offset:3072
  ds_write_b128 v7, v[32:35] offset:4096
  ds_write_b128 v7, v[36:39] offset:5120
  ds_write_b128 v7, v[40:43] offset:6144
  ds_write_b128 v7, v[44:47] offset:7168
  s_waitcnt lgkmcnt(0)
  v_mov_b32 v3, 1
  v_mov_b32 v2, 163072
  s_mov_b64 exec, 1
  ds_add_u32 v2, v3 offset:52
  s_mov_b64 exec, -1
  s_endpgm
L_compute:
  s_and_b32 s71, s64, 1
  s_lshr_b32 s72, s64, 1
  v_and_b32 v1, 15, v250
  v_lshrrev_b32 v2, 4, v250
  v_lshrrev_b32 v3, 1, v1
  v_xor_b32 v3, v3, v2
  v_lshlrev_b32 v3, 4, v3
  s_lshl_b32 s73, s72, 13
  v_lshlrev_b32 v4, 7, v1
  v_add_u32 v4, s73, v4
  v_add_u32 v176, v4, v3
  v_xor_b32 v177, 64, v176
  v_bfe_u32 v3, v250, 2, 2
  v_lshlrev_b32 v4, 3, v2
  v_add_u32 v4, v4, v3
  v_lshlrev_b32 v4, 7, v4
  v_lshrrev_b32 v3, 1, v3
  v_and_b32 v5, 1, v2
  v_lshlrev_b32 v5, 1, v5
  v_or_b32 v3, v3, v5
  v_lshlrev_b32 v3, 1, v3
  v_bfe_u32 v5, v250, 1, 1
  s_lshl_b32 s73, s71, 2
  v_or_b32 v5, s73, v5
  v_xor_b32 v3, v3, v5
  v_lshlrev_b32 v3, 4, v3
  v_add_u32 v4, v4, v3
  v_and_b32 v3, 1, v250
  v_lshlrev_b32 v3, 3, v3
  v_add_u32 v4, v4, v3
  v_add_u32 v178, 16384, v4
  v_xor_b32 v179, 32, v178
  s_mov_b32 s74, 122880
  s_getpc_b64 s[4:5]
L_pc:
  s_sub_u32 s4, s4, L_pc-gated_mix__linear_attn_block__ssm_conv_h3__prompt_kernel
  s_subb_u32 s5, s5, 0
  s_lshl_b32 s6, s64, 13
  v_lshlrev_b32 v6, 6, v250
  v_add_u32 v6, s6, v6
  v_min_u32 v7, L_end-gated_mix__linear_attn_block__ssm_conv_h3__prompt_kernel, v6
  global_load_dword v240, v7, s[4:5]
  v_add_u32 v6, 4096, v6
  v_min_u32 v7, L_end-gated_mix__linear_attn_block__ssm_conv_h3__prompt_kernel, v6
  global_load_dword v241, v7, s[4:5]
  v_add_u32 v192, 0, v176
  v_add_u32 v193, 0, v177
  v_add_u32 v194, 0, v178
  v_add_u32 v195, 0, v179
  v_add_u32 v196, 40960, v176
  v_add_u32 v197, 40960, v177
  v_add_u32 v198, 40960, v178
  v_add_u32 v199, 40960, v179
  v_add_u32 v200, 81920, v176
  v_add_u32 v201, 81920, v177
  v_add_u32 v202, 81920, v178
  v_add_u32 v203, 81920, v179
  v_add_u32 v204, 122880, v176
  v_add_u32 v205, 122880, v177
  v_add_u32 v206, 122880, v178
  v_add_u32 v207, 122880, v179
  v_mov_b32 v0, 0
  v_mov_b32 v1, 0
  v_mov_b32 v2, 0
  v_mov_b32 v3, 0
  v_mov_b32 v4, 0
  v_mov_b32 v5, 0
  v_mov_b32 v6, 0
  v_mov_b32 v7, 0
  v_mov_b32 v8, 0
  v_mov_b32 v9, 0
  v_mov_b32 v10, 0
  v_mov_b32 v11, 0
  v_mov_b32 v12, 0
  v_mov_b32 v13, 0
  v_mov_b32 v14, 0
  v_mov_b32 v15, 0
  v_mov_b32 v16, 0
  v_mov_b32 v17, 0
  v_mov_b32 v18, 0
  v_mov_b32 v19, 0
  v_mov_b32 v20, 0
  v_mov_b32 v21, 0
  v_mov_b32 v22, 0
  v_mov_b32 v23, 0
  v_mov_b32 v24, 0
  v_mov_b32 v25, 0
  v_mov_b32 v26, 0
  v_mov_b32 v27, 0
  v_mov_b32 v28, 0
  v_mov_b32 v29, 0
  v_mov_b32 v30, 0
  v_mov_b32 v31, 0
  v_mov_b32 v32, 0
  v_mov_b32 v33, 0
  v_mov_b32 v34, 0
  v_mov_b32 v35, 0
  v_mov_b32 v36, 0
  v_mov_b32 v37, 0
  v_mov_b32 v38, 0
  v_mov_b32 v39, 0
  v_mov_b32 v40, 0
  v_mov_b32 v41, 0
  v_mov_b32 v42, 0
  v_mov_b32 v43, 0
  v_mov_b32 v44, 0
  v_mov_b32 v45, 0
  v_mov_b32 v46, 0
  v_mov_b32 v47, 0
  v_mov_b32 v48, 0
  v_mov_b32 v49, 0
  v_mov_b32 v50, 0
  v_mov_b32 v51, 0
  v_mov_b32 v52, 0
  v_mov_b32 v53, 0
  v_mov_b32 v54, 0
  v_mov_b32 v55, 0
  v_mov_b32 v56, 0
  v_mov_b32 v57, 0
  v_mov_b32 v58, 0
  v_mov_b32 v59, 0
  v_mov_b32 v60, 0
  v_mov_b32 v61, 0
  v_mov_b32 v62, 0
  v_mov_b32 v63, 0
  v_mov_b32 v64, 0
  v_mov_b32 v65, 0
  v_mov_b32 v66, 0
  v_mov_b32 v67, 0
  v_mov_b32 v68, 0
  v_mov_b32 v69, 0
  v_mov_b32 v70, 0
  v_mov_b32 v71, 0
  v_mov_b32 v72, 0
  v_mov_b32 v73, 0
  v_mov_b32 v74, 0
  v_mov_b32 v75, 0
  v_mov_b32 v76, 0
  v_mov_b32 v77, 0
  v_mov_b32 v78, 0
  v_mov_b32 v79, 0
  v_mov_b32 v80, 0
  v_mov_b32 v81, 0
  v_mov_b32 v82, 0
  v_mov_b32 v83, 0
  v_mov_b32 v84, 0
  v_mov_b32 v85, 0
  v_mov_b32 v86, 0
  v_mov_b32 v87, 0
  v_mov_b32 v88, 0
  v_mov_b32 v89, 0
  v_mov_b32 v90, 0
  v_mov_b32 v91, 0
  v_mov_b32 v92, 0
  v_mov_b32 v93, 0
  v_mov_b32 v94, 0
  v_mov_b32 v95, 0
  v_mov_b32 v251, 163072
  v_mov_b32 v252, 1
  s_barrier
  ds_read_b64_tr_b16 v[112:113], v206 offset:0
  ds_read_b64_tr_b16 v[114:115], v206 offset:512
  ds_read_b64_tr_b16 v[116:117], v207 offset:0
  ds_read_b64_tr_b16 v[118:119], v207 offset:512
  ds_read_b128 v[96:99], v204 offset:0
  ds_read_b128 v[100:103], v204 offset:2048
  ds_read_b128 v[104:107], v204 offset:4096
  ds_read_b128 v[108:111], v204 offset:6144
  ds_read_b64_tr_b16 v[120:121], v206 offset:8192
  ds_read_b64_tr_b16 v[122:123], v206 offset:8704
  ds_read_b64_tr_b16 v[124:125], v207 offset:8192
  ds_read_b64_tr_b16 v[126:127], v207 offset:8704
  ds_read_b64_tr_b16 v[128:129], v206 offset:16384
  ds_read_b64_tr_b16 v[130:131], v206 offset:16896
  ds_read_b64_tr_b16 v[132:133], v207 offset:16384
  ds_read_b64_tr_b16 v[134:135], v207 offset:16896
  s_mov_b32 s75, 0
L_gemm1:
  s_waitcnt lgkmcnt(8)
  v_mfma_f32_16x16x32_bf16 v[0:3], v[112:115], v[96:99], v[0:3]
  ds_read_b64_tr_b16 v[152:153], v206 offset:4096
  v_mfma_f32_16x16x32_bf16 v[16:19], v[116:119], v[96:99], v[16:19]
  ds_read_b64_tr_b16 v[154:155], v206 offset:4608
  v_mfma_f32_16x16x32_bf16 v[4:7], v[112:115], v[100:103], v[4:7]
  ds_read_b64_tr_b16 v[156:157], v207 offset:4096
  v_mfma_f32_16x16x32_bf16 v[20:23], v[116:119], v[100:103], v[20:23]
  ds_read_b64_tr_b16 v[158:159], v207 offset:4608
  v_mfma_f32_16x16x32_bf16 v[8:11], v[112:115], v[104:107], v[8:11]
  ds_read_b128 v[136:139], v205 offset:0
  v_mfma_f32_16x16x32_bf16 v[24:27], v[116:119], v[104:107], v[24:27]
  ds_read_b128 v[140:143], v205 offset:2048
  v_mfma_f32_16x16x32_bf16 v[12:15], v[112:115], v[108:111], v[12:15]
  ds_read_b128 v[144:147], v205 offset:4096
  v_mfma_f32_16x16x32_bf16 v[28:31], v[116:119], v[108:111], v[28:31]
  s_waitcnt lgkmcnt(11)
  v_mfma_f32_16x16x32_bf16 v[32:35], v[96:99], v[120:123], v[32:35]
  ds_read_b128 v[148:151], v205 offset:6144
  v_mfma_f32_16x16x32_bf16 v[36:39], v[96:99], v[124:127], v[36:39]
  ds_read_b64_tr_b16 v[160:161], v206 offset:12288
  v_mfma_f32_16x16x32_bf16 v[40:43], v[100:103], v[120:123], v[40:43]
  ds_read_b64_tr_b16 v[162:163], v206 offset:12800
  v_mfma_f32_16x16x32_bf16 v[44:47], v[100:103], v[124:127], v[44:47]
  ds_read_b64_tr_b16 v[164:165], v207 offset:12288
  v_mfma_f32_16x16x32_bf16 v[48:51], v[104:107], v[120:123], v[48:51]
  ds_read_b64_tr_b16 v[166:167], v207 offset:12800
  v_mfma_f32_16x16x32_bf16 v[52:55], v[104:107], v[124:127], v[52:55]
  ds_read_b64_tr_b16 v[168:169], v206 offset:20480
  v_mfma_f32_16x16x32_bf16 v[56:59], v[108:111], v[120:123], v[56:59]
  ds_read_b64_tr_b16 v[170:171], v206 offset:20992
  v_mfma_f32_16x16x32_bf16 v[60:63], v[108:111], v[124:127], v[60:63]
  s_waitcnt lgkmcnt(14)
  v_mfma_f32_16x16x32_bf16 v[64:67], v[96:99], v[128:131], v[64:67]
  ds_read_b64_tr_b16 v[172:173], v207 offset:20480
  v_mfma_f32_16x16x32_bf16 v[68:71], v[96:99], v[132:135], v[68:71]
  ds_read_b64_tr_b16 v[174:175], v207 offset:20992
  v_mfma_f32_16x16x32_bf16 v[72:75], v[100:103], v[128:131], v[72:75]
  v_mfma_f32_16x16x32_bf16 v[76:79], v[100:103], v[132:135], v[76:79]
  v_mfma_f32_16x16x32_bf16 v[80:83], v[104:107], v[128:131], v[80:83]
  v_mfma_f32_16x16x32_bf16 v[84:87], v[104:107], v[132:135], v[84:87]
  v_mfma_f32_16x16x32_bf16 v[88:91], v[108:111], v[128:131], v[88:91]
  v_mfma_f32_16x16x32_bf16 v[92:95], v[108:111], v[132:135], v[92:95]
  s_waitcnt lgkmcnt(8)
  v_mfma_f32_16x16x32_bf16 v[0:3], v[152:155], v[136:139], v[0:3]
  v_mfma_f32_16x16x32_bf16 v[16:19], v[156:159], v[136:139], v[16:19]
  v_mfma_f32_16x16x32_bf16 v[4:7], v[152:155], v[140:143], v[4:7]
  v_mfma_f32_16x16x32_bf16 v[20:23], v[156:159], v[140:143], v[20:23]
  v_mfma_f32_16x16x32_bf16 v[8:11], v[152:155], v[144:147], v[8:11]
  v_mfma_f32_16x16x32_bf16 v[24:27], v[156:159], v[144:147], v[24:27]
  s_waitcnt lgkmcnt(0)
  s_barrier
  v_mfma_f32_16x16x32_bf16 v[12:15], v[152:155], v[148:151], v[12:15]
  ds_read_b64_tr_b16 v[112:113], v194 offset:0
  v_mfma_f32_16x16x32_bf16 v[28:31], v[156:159], v[148:151], v[28:31]
  v_mfma_f32_16x16x32_bf16 v[32:35], v[136:139], v[160:163], v[32:35]
  ds_read_b64_tr_b16 v[114:115], v194 offset:512
  v_mfma_f32_16x16x32_bf16 v[36:39], v[136:139], v[164:167], v[36:39]
  ds_read_b64_tr_b16 v[116:117], v195 offset:0
  v_mfma_f32_16x16x32_bf16 v[40:43], v[140:143], v[160:163], v[40:43]
  ds_read_b64_tr_b16 v[118:119], v195 offset:512
  v_mfma_f32_16x16x32_bf16 v[44:47], v[140:143], v[164:167], v[44:47]
  ds_read_b128 v[96:99], v192 offset:0
  v_mfma_f32_16x16x32_bf16 v[48:51], v[144:147], v[160:163], v[48:51]
  ds_read_b128 v[100:103], v192 offset:2048
  v_mfma_f32_16x16x32_bf16 v[52:55], v[144:147], v[164:167], v[52:55]
  ds_read_b128 v[104:107], v192 offset:4096
  v_mfma_f32_16x16x32_bf16 v[56:59], v[148:151], v[160:163], v[56:59]
  ds_read_b128 v[108:111], v192 offset:6144
  v_mfma_f32_16x16x32_bf16 v[60:63], v[148:151], v[164:167], v[60:63]
  v_mfma_f32_16x16x32_bf16 v[64:67], v[136:139], v[168:171], v[64:67]
  ds_read_b64_tr_b16 v[120:121], v194 offset:8192
  v_mfma_f32_16x16x32_bf16 v[68:71], v[136:139], v[172:175], v[68:71]
  ds_read_b64_tr_b16 v[122:123], v194 offset:8704
  v_mfma_f32_16x16x32_bf16 v[72:75], v[140:143], v[168:171], v[72:75]
  ds_read_b64_tr_b16 v[124:125], v195 offset:8192
  v_mfma_f32_16x16x32_bf16 v[76:79], v[140:143], v[172:175], v[76:79]
  ds_read_b64_tr_b16 v[126:127], v195 offset:8704
  v_mfma_f32_16x16x32_bf16 v[80:83], v[144:147], v[168:171], v[80:83]
  ds_read_b64_tr_b16 v[128:129], v194 offset:16384
  v_mfma_f32_16x16x32_bf16 v[84:87], v[144:147], v[172:175], v[84:87]
  ds_read_b64_tr_b16 v[130:131], v194 offset:16896
  v_mfma_f32_16x16x32_bf16 v[88:91], v[148:151], v[168:171], v[88:91]
  ds_read_b64_tr_b16 v[132:133], v195 offset:16384
  v_mfma_f32_16x16x32_bf16 v[92:95], v[148:151], v[172:175], v[92:95]
  ds_read_b64_tr_b16 v[134:135], v195 offset:16896
  s_waitcnt lgkmcnt(8)
  v_mfma_f32_16x16x32_bf16 v[0:3], v[112:115], v[96:99], v[0:3]
  ds_read_b64_tr_b16 v[152:153], v194 offset:4096
  v_mfma_f32_16x16x32_bf16 v[16:19], v[116:119], v[96:99], v[16:19]
  ds_read_b64_tr_b16 v[154:155], v194 offset:4608
  v_mfma_f32_16x16x32_bf16 v[4:7], v[112:115], v[100:103], v[4:7]
  ds_read_b64_tr_b16 v[156:157], v195 offset:4096
  v_mfma_f32_16x16x32_bf16 v[20:23], v[116:119], v[100:103], v[20:23]
  ds_read_b64_tr_b16 v[158:159], v195 offset:4608
  v_mfma_f32_16x16x32_bf16 v[8:11], v[112:115], v[104:107], v[8:11]
  ds_read_b128 v[136:139], v193 offset:0
  v_mfma_f32_16x16x32_bf16 v[24:27], v[116:119], v[104:107], v[24:27]
  ds_read_b128 v[140:143], v193 offset:2048
  v_mfma_f32_16x16x32_bf16 v[12:15], v[112:115], v[108:111], v[12:15]
  ds_read_b128 v[144:147], v193 offset:4096
  v_mfma_f32_16x16x32_bf16 v[28:31], v[116:119], v[108:111], v[28:31]
  s_waitcnt lgkmcnt(11)
  v_mfma_f32_16x16x32_bf16 v[32:35], v[96:99], v[120:123], v[32:35]
  ds_read_b128 v[148:151], v193 offset:6144
  v_mfma_f32_16x16x32_bf16 v[36:39], v[96:99], v[124:127], v[36:39]
  ds_read_b64_tr_b16 v[160:161], v194 offset:12288
  v_mfma_f32_16x16x32_bf16 v[40:43], v[100:103], v[120:123], v[40:43]
  ds_read_b64_tr_b16 v[162:163], v194 offset:12800
  v_mfma_f32_16x16x32_bf16 v[44:47], v[100:103], v[124:127], v[44:47]
  ds_read_b64_tr_b16 v[164:165], v195 offset:12288
  v_mfma_f32_16x16x32_bf16 v[48:51], v[104:107], v[120:123], v[48:51]
  ds_read_b64_tr_b16 v[166:167], v195 offset:12800
  v_mfma_f32_16x16x32_bf16 v[52:55], v[104:107], v[124:127], v[52:55]
  ds_read_b64_tr_b16 v[168:169], v194 offset:20480
  v_mfma_f32_16x16x32_bf16 v[56:59], v[108:111], v[120:123], v[56:59]
  ds_read_b64_tr_b16 v[170:171], v194 offset:20992
  v_mfma_f32_16x16x32_bf16 v[60:63], v[108:111], v[124:127], v[60:63]
  s_waitcnt lgkmcnt(14)
  v_mfma_f32_16x16x32_bf16 v[64:67], v[96:99], v[128:131], v[64:67]
  ds_read_b64_tr_b16 v[172:173], v195 offset:20480
  v_mfma_f32_16x16x32_bf16 v[68:71], v[96:99], v[132:135], v[68:71]
  ds_read_b64_tr_b16 v[174:175], v195 offset:20992
  v_mfma_f32_16x16x32_bf16 v[72:75], v[100:103], v[128:131], v[72:75]
  v_mfma_f32_16x16x32_bf16 v[76:79], v[100:103], v[132:135], v[76:79]
  v_mfma_f32_16x16x32_bf16 v[80:83], v[104:107], v[128:131], v[80:83]
  v_mfma_f32_16x16x32_bf16 v[84:87], v[104:107], v[132:135], v[84:87]
  v_mfma_f32_16x16x32_bf16 v[88:91], v[108:111], v[128:131], v[88:91]
  v_mfma_f32_16x16x32_bf16 v[92:95], v[108:111], v[132:135], v[92:95]
  s_waitcnt lgkmcnt(8)
  v_mfma_f32_16x16x32_bf16 v[0:3], v[152:155], v[136:139], v[0:3]
  v_mfma_f32_16x16x32_bf16 v[16:19], v[156:159], v[136:139], v[16:19]
  v_mfma_f32_16x16x32_bf16 v[4:7], v[152:155], v[140:143], v[4:7]
  v_mfma_f32_16x16x32_bf16 v[20:23], v[156:159], v[140:143], v[20:23]
  v_mfma_f32_16x16x32_bf16 v[8:11], v[152:155], v[144:147], v[8:11]
  v_mfma_f32_16x16x32_bf16 v[24:27], v[156:159], v[144:147], v[24:27]
  s_waitcnt lgkmcnt(0)
  s_barrier
  v_mfma_f32_16x16x32_bf16 v[12:15], v[152:155], v[148:151], v[12:15]
  ds_read_b64_tr_b16 v[112:113], v198 offset:0
  v_mfma_f32_16x16x32_bf16 v[28:31], v[156:159], v[148:151], v[28:31]
  v_mfma_f32_16x16x32_bf16 v[32:35], v[136:139], v[160:163], v[32:35]
  ds_read_b64_tr_b16 v[114:115], v198 offset:512
  v_mfma_f32_16x16x32_bf16 v[36:39], v[136:139], v[164:167], v[36:39]
  ds_read_b64_tr_b16 v[116:117], v199 offset:0
  v_mfma_f32_16x16x32_bf16 v[40:43], v[140:143], v[160:163], v[40:43]
  ds_read_b64_tr_b16 v[118:119], v199 offset:512
  v_mfma_f32_16x16x32_bf16 v[44:47], v[140:143], v[164:167], v[44:47]
  ds_read_b128 v[96:99], v196 offset:0
  v_mfma_f32_16x16x32_bf16 v[48:51], v[144:147], v[160:163], v[48:51]
  ds_read_b128 v[100:103], v196 offset:2048
  v_mfma_f32_16x16x32_bf16 v[52:55], v[144:147], v[164:167], v[52:55]
  ds_read_b128 v[104:107], v196 offset:4096
  v_mfma_f32_16x16x32_bf16 v[56:59], v[148:151], v[160:163], v[56:59]
  ds_read_b128 v[108:111], v196 offset:6144
  v_mfma_f32_16x16x32_bf16 v[60:63], v[148:151], v[164:167], v[60:63]
  v_mfma_f32_16x16x32_bf16 v[64:67], v[136:139], v[168:171], v[64:67]
  ds_read_b64_tr_b16 v[120:121], v198 offset:8192
  v_mfma_f32_16x16x32_bf16 v[68:71], v[136:139], v[172:175], v[68:71]
  ds_read_b64_tr_b16 v[122:123], v198 offset:8704
  v_mfma_f32_16x16x32_bf16 v[72:75], v[140:143], v[168:171], v[72:75]
  ds_read_b64_tr_b16 v[124:125], v199 offset:8192
  v_mfma_f32_16x16x32_bf16 v[76:79], v[140:143], v[172:175], v[76:79]
  ds_read_b64_tr_b16 v[126:127], v199 offset:8704
  v_mfma_f32_16x16x32_bf16 v[80:83], v[144:147], v[168:171], v[80:83]
  ds_read_b64_tr_b16 v[128:129], v198 offset:16384
  v_mfma_f32_16x16x32_bf16 v[84:87], v[144:147], v[172:175], v[84:87]
  ds_read_b64_tr_b16 v[130:131], v198 offset:16896
  v_mfma_f32_16x16x32_bf16 v[88:91], v[148:151], v[168:171], v[88:91]
  ds_read_b64_tr_b16 v[132:133], v199 offset:16384
  v_mfma_f32_16x16x32_bf16 v[92:95], v[148:151], v[172:175], v[92:95]
  ds_read_b64_tr_b16 v[134:135], v199 offset:16896
  s_waitcnt lgkmcnt(8)
  v_mfma_f32_16x16x32_bf16 v[0:3], v[112:115], v[96:99], v[0:3]
  ds_read_b64_tr_b16 v[152:153], v198 offset:4096
  v_mfma_f32_16x16x32_bf16 v[16:19], v[116:119], v[96:99], v[16:19]
  ds_read_b64_tr_b16 v[154:155], v198 offset:4608
  v_mfma_f32_16x16x32_bf16 v[4:7], v[112:115], v[100:103], v[4:7]
  ds_read_b64_tr_b16 v[156:157], v199 offset:4096
  v_mfma_f32_16x16x32_bf16 v[20:23], v[116:119], v[100:103], v[20:23]
  ds_read_b64_tr_b16 v[158:159], v199 offset:4608
  v_mfma_f32_16x16x32_bf16 v[8:11], v[112:115], v[104:107], v[8:11]
  ds_read_b128 v[136:139], v197 offset:0
  v_mfma_f32_16x16x32_bf16 v[24:27], v[116:119], v[104:107], v[24:27]
  ds_read_b128 v[140:143], v197 offset:2048
  v_mfma_f32_16x16x32_bf16 v[12:15], v[112:115], v[108:111], v[12:15]
  ds_read_b128 v[144:147], v197 offset:4096
  v_mfma_f32_16x16x32_bf16 v[28:31], v[116:119], v[108:111], v[28:31]
  s_waitcnt lgkmcnt(11)
  v_mfma_f32_16x16x32_bf16 v[32:35], v[96:99], v[120:123], v[32:35]
  ds_read_b128 v[148:151], v197 offset:6144
  v_mfma_f32_16x16x32_bf16 v[36:39], v[96:99], v[124:127], v[36:39]
  ds_read_b64_tr_b16 v[160:161], v198 offset:12288
  v_mfma_f32_16x16x32_bf16 v[40:43], v[100:103], v[120:123], v[40:43]
  ds_read_b64_tr_b16 v[162:163], v198 offset:12800
  v_mfma_f32_16x16x32_bf16 v[44:47], v[100:103], v[124:127], v[44:47]
  ds_read_b64_tr_b16 v[164:165], v199 offset:12288
  v_mfma_f32_16x16x32_bf16 v[48:51], v[104:107], v[120:123], v[48:51]
  ds_read_b64_tr_b16 v[166:167], v199 offset:12800
  v_mfma_f32_16x16x32_bf16 v[52:55], v[104:107], v[124:127], v[52:55]
  ds_read_b64_tr_b16 v[168:169], v198 offset:20480
  v_mfma_f32_16x16x32_bf16 v[56:59], v[108:111], v[120:123], v[56:59]
  ds_read_b64_tr_b16 v[170:171], v198 offset:20992
  v_mfma_f32_16x16x32_bf16 v[60:63], v[108:111], v[124:127], v[60:63]
  s_waitcnt lgkmcnt(14)
  v_mfma_f32_16x16x32_bf16 v[64:67], v[96:99], v[128:131], v[64:67]
  ds_read_b64_tr_b16 v[172:173], v199 offset:20480
  v_mfma_f32_16x16x32_bf16 v[68:71], v[96:99], v[132:135], v[68:71]
  ds_read_b64_tr_b16 v[174:175], v199 offset:20992
  v_mfma_f32_16x16x32_bf16 v[72:75], v[100:103], v[128:131], v[72:75]
  v_mfma_f32_16x16x32_bf16 v[76:79], v[100:103], v[132:135], v[76:79]
  v_mfma_f32_16x16x32_bf16 v[80:83], v[104:107], v[128:131], v[80:83]
  v_mfma_f32_16x16x32_bf16 v[84:87], v[104:107], v[132:135], v[84:87]
  v_mfma_f32_16x16x32_bf16 v[88:91], v[108:111], v[128:131], v[88:91]
  v_mfma_f32_16x16x32_bf16 v[92:95], v[108:111], v[132:135], v[92:95]
  s_waitcnt lgkmcnt(8)
  v_mfma_f32_16x16x32_bf16 v[0:3], v[152:155], v[136:139], v[0:3]
  v_mfma_f32_16x16x32_bf16 v[16:19], v[156:159], v[136:139], v[16:19]
  v_mfma_f32_16x16x32_bf16 v[4:7], v[152:155], v[140:143], v[4:7]
  v_mfma_f32_16x16x32_bf16 v[20:23], v[156:159], v[140:143], v[20:23]
  v_mfma_f32_16x16x32_bf16 v[8:11], v[152:155], v[144:147], v[8:11]
  v_mfma_f32_16x16x32_bf16 v[24:27], v[156:159], v[144:147], v[24:27]
  s_waitcnt lgkmcnt(0)
  s_barrier
  v_mfma_f32_16x16x32_bf16 v[12:15], v[152:155], v[148:151], v[12:15]
  ds_read_b64_tr_b16 v[112:113], v202 offset:0
  v_mfma_f32_16x16x32_bf16 v[28:31], v[156:159], v[148:151], v[28:31]
  v_mfma_f32_16x16x32_bf16 v[32:35], v[136:139], v[160:163], v[32:35]
  ds_read_b64_tr_b16 v[114:115], v202 offset:512
  v_mfma_f32_16x16x32_bf16 v[36:39], v[136:139], v[164:167], v[36:39]
  ds_read_b64_tr_b16 v[116:117], v203 offset:0
  v_mfma_f32_16x16x32_bf16 v[40:43], v[140:143], v[160:163], v[40:43]
  ds_read_b64_tr_b16 v[118:119], v203 offset:512
  v_mfma_f32_16x16x32_bf16 v[44:47], v[140:143], v[164:167], v[44:47]
  ds_read_b128 v[96:99], v200 offset:0
  v_mfma_f32_16x16x32_bf16 v[48:51], v[144:147], v[160:163], v[48:51]
  ds_read_b128 v[100:103], v200 offset:2048
  v_mfma_f32_16x16x32_bf16 v[52:55], v[144:147], v[164:167], v[52:55]
  ds_read_b128 v[104:107], v200 offset:4096
  v_mfma_f32_16x16x32_bf16 v[56:59], v[148:151], v[160:163], v[56:59]
  ds_read_b128 v[108:111], v200 offset:6144
  v_mfma_f32_16x16x32_bf16 v[60:63], v[148:151], v[164:167], v[60:63]
  v_mfma_f32_16x16x32_bf16 v[64:67], v[136:139], v[168:171], v[64:67]
  ds_read_b64_tr_b16 v[120:121], v202 offset:8192
  v_mfma_f32_16x16x32_bf16 v[68:71], v[136:139], v[172:175], v[68:71]
  ds_read_b64_tr_b16 v[122:123], v202 offset:8704
  v_mfma_f32_16x16x32_bf16 v[72:75], v[140:143], v[168:171], v[72:75]
  ds_read_b64_tr_b16 v[124:125], v203 offset:8192
  v_mfma_f32_16x16x32_bf16 v[76:79], v[140:143], v[172:175], v[76:79]
  ds_read_b64_tr_b16 v[126:127], v203 offset:8704
  v_mfma_f32_16x16x32_bf16 v[80:83], v[144:147], v[168:171], v[80:83]
  ds_read_b64_tr_b16 v[128:129], v202 offset:16384
  v_mfma_f32_16x16x32_bf16 v[84:87], v[144:147], v[172:175], v[84:87]
  ds_read_b64_tr_b16 v[130:131], v202 offset:16896
  v_mfma_f32_16x16x32_bf16 v[88:91], v[148:151], v[168:171], v[88:91]
  ds_read_b64_tr_b16 v[132:133], v203 offset:16384
  v_mfma_f32_16x16x32_bf16 v[92:95], v[148:151], v[172:175], v[92:95]
  ds_read_b64_tr_b16 v[134:135], v203 offset:16896
  s_waitcnt lgkmcnt(8)
  v_mfma_f32_16x16x32_bf16 v[0:3], v[112:115], v[96:99], v[0:3]
  ds_read_b64_tr_b16 v[152:153], v202 offset:4096
  v_mfma_f32_16x16x32_bf16 v[16:19], v[116:119], v[96:99], v[16:19]
  ds_read_b64_tr_b16 v[154:155], v202 offset:4608
  v_mfma_f32_16x16x32_bf16 v[4:7], v[112:115], v[100:103], v[4:7]
  ds_read_b64_tr_b16 v[156:157], v203 offset:4096
  v_mfma_f32_16x16x32_bf16 v[20:23], v[116:119], v[100:103], v[20:23]
  ds_read_b64_tr_b16 v[158:159], v203 offset:4608
  v_mfma_f32_16x16x32_bf16 v[8:11], v[112:115], v[104:107], v[8:11]
  ds_read_b128 v[136:139], v201 offset:0
  v_mfma_f32_16x16x32_bf16 v[24:27], v[116:119], v[104:107], v[24:27]
  ds_read_b128 v[140:143], v201 offset:2048
  v_mfma_f32_16x16x32_bf16 v[12:15], v[112:115], v[108:111], v[12:15]
  ds_read_b128 v[144:147], v201 offset:4096
  v_mfma_f32_16x16x32_bf16 v[28:31], v[116:119], v[108:111], v[28:31]
  s_waitcnt lgkmcnt(11)
  v_mfma_f32_16x16x32_bf16 v[32:35], v[96:99], v[120:123], v[32:35]
  ds_read_b128 v[148:151], v201 offset:6144
  v_mfma_f32_16x16x32_bf16 v[36:39], v[96:99], v[124:127], v[36:39]
  ds_read_b64_tr_b16 v[160:161], v202 offset:12288
  v_mfma_f32_16x16x32_bf16 v[40:43], v[100:103], v[120:123], v[40:43]
  ds_read_b64_tr_b16 v[162:163], v202 offset:12800
  v_mfma_f32_16x16x32_bf16 v[44:47], v[100:103], v[124:127], v[44:47]
  ds_read_b64_tr_b16 v[164:165], v203 offset:12288
  v_mfma_f32_16x16x32_bf16 v[48:51], v[104:107], v[120:123], v[48:51]
  ds_read_b64_tr_b16 v[166:167], v203 offset:12800
  v_mfma_f32_16x16x32_bf16 v[52:55], v[104:107], v[124:127], v[52:55]
  ds_read_b64_tr_b16 v[168:169], v202 offset:20480
  v_mfma_f32_16x16x32_bf16 v[56:59], v[108:111], v[120:123], v[56:59]
  ds_read_b64_tr_b16 v[170:171], v202 offset:20992
  v_mfma_f32_16x16x32_bf16 v[60:63], v[108:111], v[124:127], v[60:63]
  s_waitcnt lgkmcnt(14)
  v_mfma_f32_16x16x32_bf16 v[64:67], v[96:99], v[128:131], v[64:67]
  ds_read_b64_tr_b16 v[172:173], v203 offset:20480
  v_mfma_f32_16x16x32_bf16 v[68:71], v[96:99], v[132:135], v[68:71]
  ds_read_b64_tr_b16 v[174:175], v203 offset:20992
  v_mfma_f32_16x16x32_bf16 v[72:75], v[100:103], v[128:131], v[72:75]
  v_mfma_f32_16x16x32_bf16 v[76:79], v[100:103], v[132:135], v[76:79]
  v_mfma_f32_16x16x32_bf16 v[80:83], v[104:107], v[128:131], v[80:83]
  v_mfma_f32_16x16x32_bf16 v[84:87], v[104:107], v[132:135], v[84:87]
  v_mfma_f32_16x16x32_bf16 v[88:91], v[108:111], v[128:131], v[88:91]
  v_mfma_f32_16x16x32_bf16 v[92:95], v[108:111], v[132:135], v[92:95]
  s_waitcnt lgkmcnt(8)
  v_mfma_f32_16x16x32_bf16 v[0:3], v[152:155], v[136:139], v[0:3]
  v_mfma_f32_16x16x32_bf16 v[16:19], v[156:159], v[136:139], v[16:19]
  v_mfma_f32_16x16x32_bf16 v[4:7], v[152:155], v[140:143], v[4:7]
  v_mfma_f32_16x16x32_bf16 v[20:23], v[156:159], v[140:143], v[20:23]
  v_mfma_f32_16x16x32_bf16 v[8:11], v[152:155], v[144:147], v[8:11]
  v_mfma_f32_16x16x32_bf16 v[24:27], v[156:159], v[144:147], v[24:27]
  s_waitcnt lgkmcnt(0)
  s_cmp_eq_u32 s75, 3
  s_cbranch_scc1 L_g1_last
  s_barrier
  s_branch L_g1_nobar
L_g1_last:
  s_mov_b64 exec, 1
  ds_add_u32 v251, v252 offset:40
  s_mov_b64 exec, -1
L_g1_nobar:
  v_mfma_f32_16x16x32_bf16 v[12:15], v[152:155], v[148:151], v[12:15]
  ds_read_b64_tr_b16 v[112:113], v206 offset:0
  v_mfma_f32_16x16x32_bf16 v[28:31], v[156:159], v[148:151], v[28:31]
  v_mfma_f32_16x16x32_bf16 v[32:35], v[136:139], v[160:163], v[32:35]
  ds_read_b64_tr_b16 v[114:115], v206 offset:512
  v_mfma_f32_16x16x32_bf16 v[36:39], v[136:139], v[164:167], v[36:39]
  ds_read_b64_tr_b16 v[116:117], v207 offset:0
  v_mfma_f32_16x16x32_bf16 v[40:43], v[140:143], v[160:163], v[40:43]
  ds_read_b64_tr_b16 v[118:119], v207 offset:512
  v_mfma_f32_16x16x32_bf16 v[44:47], v[140:143], v[164:167], v[44:47]
  ds_read_b128 v[96:99], v204 offset:0
  v_mfma_f32_16x16x32_bf16 v[48:51], v[144:147], v[160:163], v[48:51]
  ds_read_b128 v[100:103], v204 offset:2048
  v_mfma_f32_16x16x32_bf16 v[52:55], v[144:147], v[164:167], v[52:55]
  ds_read_b128 v[104:107], v204 offset:4096
  v_mfma_f32_16x16x32_bf16 v[56:59], v[148:151], v[160:163], v[56:59]
  ds_read_b128 v[108:111], v204 offset:6144
  v_mfma_f32_16x16x32_bf16 v[60:63], v[148:151], v[164:167], v[60:63]
  v_mfma_f32_16x16x32_bf16 v[64:67], v[136:139], v[168:171], v[64:67]
  ds_read_b64_tr_b16 v[120:121], v206 offset:8192
  v_mfma_f32_16x16x32_bf16 v[68:71], v[136:139], v[172:175], v[68:71]
  ds_read_b64_tr_b16 v[122:123], v206 offset:8704
  v_mfma_f32_16x16x32_bf16 v[72:75], v[140:143], v[168:171], v[72:75]
  ds_read_b64_tr_b16 v[124:125], v207 offset:8192
  v_mfma_f32_16x16x32_bf16 v[76:79], v[140:143], v[172:175], v[76:79]
  ds_read_b64_tr_b16 v[126:127], v207 offset:8704
  v_mfma_f32_16x16x32_bf16 v[80:83], v[144:147], v[168:171], v[80:83]
  ds_read_b64_tr_b16 v[128:129], v206 offset:16384
  v_mfma_f32_16x16x32_bf16 v[84:87], v[144:147], v[172:175], v[84:87]
  ds_read_b64_tr_b16 v[130:131], v206 offset:16896
  v_mfma_f32_16x16x32_bf16 v[88:91], v[148:151], v[168:171], v[88:91]
  ds_read_b64_tr_b16 v[132:133], v207 offset:16384
  v_mfma_f32_16x16x32_bf16 v[92:95], v[148:151], v[172:175], v[92:95]
  ds_read_b64_tr_b16 v[134:135], v207 offset:16896
  s_add_u32 s75, s75, 1
  s_cmp_lt_u32 s75, 4
  s_cbranch_scc1 L_gemm1
  s_setprio 1
  s_mov_b32 s8, 0x3fb8aa3b
  s_mov_b32 s9, 0x3fb8aa3b
  s_mov_b32 s10, 0x358637bd
  s_mov_b32 s11, 0x358637bd
  s_mov_b32 s12, 1.0
  s_mov_b32 s13, 1.0
  v_lshlrev_b32 v224, 4, v250
  v_mov_b32 v230, 163072
  v_mov_b32 v160, 0x3f803f80
  v_mov_b32 v161, 0x3f803f80
  v_mov_b32 v162, 0x3f803f80
  v_mov_b32 v163, 0x3f803f80
  s_waitcnt lgkmcnt(0)
  ds_read_b32 v231, v230 offset:60
  s_nop 3
  v_pk_mul_f32 v[96:97], v[32:33], s[8:9]
  v_pk_mul_f32 v[98:99], v[34:35], s[8:9]
  v_pk_mul_f32 v[100:101], v[36:37], s[8:9]
  v_pk_mul_f32 v[102:103], v[38:39], s[8:9]
  v_pk_mul_f32 v[104:105], v[40:41], s[8:9]
  v_pk_mul_f32 v[106:107], v[42:43], s[8:9]
  v_pk_mul_f32 v[108:109], v[44:45], s[8:9]
  v_pk_mul_f32 v[110:111], v[46:47], s[8:9]
  v_pk_mul_f32 v[112:113], v[48:49], s[8:9]
  v_pk_mul_f32 v[114:115], v[50:51], s[8:9]
  v_pk_mul_f32 v[116:117], v[52:53], s[8:9]
  v_pk_mul_f32 v[118:119], v[54:55], s[8:9]
  v_pk_mul_f32 v[120:121], v[56:57], s[8:9]
  v_pk_mul_f32 v[122:123], v[58:59], s[8:9]
  v_pk_mul_f32 v[124:125], v[60:61], s[8:9]
  v_pk_mul_f32 v[126:127], v[62:63], s[8:9]
  v_exp_f32 v96, v96 clamp
  v_exp_f32 v97, v97 clamp
  v_exp_f32 v98, v98 clamp
  v_exp_f32 v99, v99 clamp
  v_exp_f32 v100, v100 clamp
  v_exp_f32 v101, v101 clamp
  v_exp_f32 v102, v102 clamp
  v_exp_f32 v103, v103 clamp
  v_exp_f32 v104, v104 clamp
  v_exp_f32 v105, v105 clamp
  v_exp_f32 v106, v106 clamp
  v_exp_f32 v107, v107 clamp
  v_exp_f32 v108, v108 clamp
  v_exp_f32 v109, v109 clamp
  v_exp_f32 v110, v110 clamp
  v_exp_f32 v111, v111 clamp
  v_exp_f32 v112, v112 clamp
  v_exp_f32 v113, v113 clamp
  v_exp_f32 v114, v114 clamp
  v_exp_f32 v115, v115 clamp
  v_exp_f32 v116, v116 clamp
  v_exp_f32 v117, v117 clamp
  v_exp_f32 v118, v118 clamp
  v_exp_f32 v119, v119 clamp
  v_exp_f32 v120, v120 clamp
  v_exp_f32 v121, v121 clamp
  v_exp_f32 v122, v122 clamp
  v_exp_f32 v123, v123 clamp
  v_exp_f32 v124, v124 clamp
  v_exp_f32 v125, v125 clamp
  v_exp_f32 v126, v126 clamp
  v_exp_f32 v127, v127 clamp
  v_pk_add_f32 v[32:33], v[32:33], s[12:13]
  v_pk_add_f32 v[34:35], v[34:35], s[12:13]
  v_pk_add_f32 v[36:37], v[36:37], s[12:13]
  v_pk_add_f32 v[38:39], v[38:39], s[12:13]
  v_pk_add_f32 v[40:41], v[40:41], s[12:13]
  v_pk_add_f32 v[42:43], v[42:43], s[12:13]
  v_pk_add_f32 v[44:45], v[44:45], s[12:13]
  v_pk_add_f32 v[46:47], v[46:47], s[12:13]
  v_pk_add_f32 v[48:49], v[48:49], s[12:13]
  v_pk_add_f32 v[50:51], v[50:51], s[12:13]
  v_pk_add_f32 v[52:53], v[52:53], s[12:13]
  v_pk_add_f32 v[54:55], v[54:55], s[12:13]
  v_pk_add_f32 v[56:57], v[56:57], s[12:13]
  v_pk_add_f32 v[58:59], v[58:59], s[12:13]
  v_pk_add_f32 v[60:61], v[60:61], s[12:13]
  v_pk_add_f32 v[62:63], v[62:63], s[12:13]
  v_max_f32 v32, v32, v96
  v_max_f32 v33, v33, v97
  v_max_f32 v34, v34, v98
  v_max_f32 v35, v35, v99
  v_max_f32 v36, v36, v100
  v_max_f32 v37, v37, v101
  v_max_f32 v38, v38, v102
  v_max_f32 v39, v39, v103
  v_max_f32 v40, v40, v104
  v_max_f32 v41, v41, v105
  v_max_f32 v42, v42, v106
  v_max_f32 v43, v43, v107
  v_max_f32 v44, v44, v108
  v_max_f32 v45, v45, v109
  v_max_f32 v46, v46, v110
  v_max_f32 v47, v47, v111
  v_max_f32 v48, v48, v112
  v_max_f32 v49, v49, v113
  v_max_f32 v50, v50, v114
  v_max_f32 v51, v51, v115
  v_max_f32 v52, v52, v116
  v_max_f32 v53, v53, v117
  v_max_f32 v54, v54, v118
  v_max_f32 v55, v55, v119
  v_max_f32 v56, v56, v120
  v_max_f32 v57, v57, v121
  v_max_f32 v58, v58, v122
  v_max_f32 v59, v59, v123
  v_max_f32 v60, v60, v124
  v_max_f32 v61, v61, v125
  v_max_f32 v62, v62, v126
  v_max_f32 v63, v63, v127
  v_pk_add_f32 v[32:33], v[32:33], s[10:11]
  v_pk_add_f32 v[34:35], v[34:35], s[10:11]
  v_pk_add_f32 v[36:37], v[36:37], s[10:11]
  v_pk_add_f32 v[38:39], v[38:39], s[10:11]
  v_pk_add_f32 v[40:41], v[40:41], s[10:11]
  v_pk_add_f32 v[42:43], v[42:43], s[10:11]
  v_pk_add_f32 v[44:45], v[44:45], s[10:11]
  v_pk_add_f32 v[46:47], v[46:47], s[10:11]
  v_pk_add_f32 v[48:49], v[48:49], s[10:11]
  v_pk_add_f32 v[50:51], v[50:51], s[10:11]
  v_pk_add_f32 v[52:53], v[52:53], s[10:11]
  v_pk_add_f32 v[54:55], v[54:55], s[10:11]
  v_pk_add_f32 v[56:57], v[56:57], s[10:11]
  v_pk_add_f32 v[58:59], v[58:59], s[10:11]
  v_pk_add_f32 v[60:61], v[60:61], s[10:11]
  v_pk_add_f32 v[62:63], v[62:63], s[10:11]
  v_cvt_pk_bf16_f32 v128, v32, v33
  v_cvt_pk_bf16_f32 v129, v34, v35
  v_cvt_pk_bf16_f32 v130, v40, v41
  v_cvt_pk_bf16_f32 v131, v42, v43
  v_cvt_pk_bf16_f32 v132, v36, v37
  v_cvt_pk_bf16_f32 v133, v38, v39
  v_cvt_pk_bf16_f32 v134, v44, v45
  v_cvt_pk_bf16_f32 v135, v46, v47
  v_cvt_pk_bf16_f32 v144, v64, v65
  v_cvt_pk_bf16_f32 v145, v66, v67
  v_cvt_pk_bf16_f32 v146, v72, v73
  v_cvt_pk_bf16_f32 v147, v74, v75
  v_cvt_pk_bf16_f32 v148, v68, v69
  v_cvt_pk_bf16_f32 v149, v70, v71
  v_cvt_pk_bf16_f32 v150, v76, v77
  v_cvt_pk_bf16_f32 v151, v78, v79
  v_cvt_pk_bf16_f32 v136, v48, v49
  v_cvt_pk_bf16_f32 v137, v50, v51
  v_cvt_pk_bf16_f32 v138, v56, v57
  v_cvt_pk_bf16_f32 v139, v58, v59
  v_cvt_pk_bf16_f32 v140, v52, v53
  v_cvt_pk_bf16_f32 v141, v54, v55
  v_cvt_pk_bf16_f32 v142, v60, v61
  v_cvt_pk_bf16_f32 v143, v62, v63
  v_cvt_pk_bf16_f32 v152, v80, v81
  v_cvt_pk_bf16_f32 v153, v82, v83
  v_cvt_pk_bf16_f32 v154, v88, v89
  v_cvt_pk_bf16_f32 v155, v90, v91
  v_cvt_pk_bf16_f32 v156, v84, v85
  v_cvt_pk_bf16_f32 v157, v86, v87
  v_cvt_pk_bf16_f32 v158, v92, v93
  v_cvt_pk_bf16_f32 v159, v94, v95
  s_waitcnt lgkmcnt(0)
  v_readfirstlane_b32 s68, v231
  v_mfma_f32_16x16x32_bf16 v[164:167], v[128:131], v[144:147], 0
  v_mfma_f32_16x16x32_bf16 v[168:171], v[128:131], v[148:151], 0
  v_mfma_f32_16x16x32_bf16 v[180:183], v[128:131], v[160:163], 0
  v_mfma_f32_16x16x32_bf16 v[172:175], v[132:135], v[144:147], 0
  v_mfma_f32_16x16x32_bf16 v[176:179], v[132:135], v[148:151], 0
  v_mfma_f32_16x16x32_bf16 v[184:187], v[132:135], v[160:163], 0
  v_mfma_f32_16x16x32_bf16 v[164:167], v[136:139], v[152:155], v[164:167]
  v_mfma_f32_16x16x32_bf16 v[168:171], v[136:139], v[156:159], v[168:171]
  v_mfma_f32_16x16x32_bf16 v[180:183], v[136:139], v[160:163], v[180:183]
  v_mfma_f32_16x16x32_bf16 v[172:175], v[140:143], v[152:155], v[172:175]
  v_mfma_f32_16x16x32_bf16 v[176:179], v[140:143], v[156:159], v[176:179]
  v_mfma_f32_16x16x32_bf16 v[184:187], v[140:143], v[160:163], v[184:187]
  s_lshl_b32 s78, s71, 12
  s_add_u32 s78, s78, 150528
  v_add_u32 v226, s78, v224
  v_lshrrev_b32 v227, 4, v250
  v_lshlrev_b32 v227, 4, v227
  s_lshl_b32 s78, s71, 7
  s_add_u32 s78, s78, 158720
  v_add_u32 v228, s78, v227
  s_lshl_b32 s79, s71, 2
  v_add_u32 v229, s79, v230
  s_lshl_b32 s80, s66, 1
  s_add_u32 s80, s80, s71
  s_cmp_eq_u32 s72, 0
  s_cbranch_scc1 L_kvlower
  ds_write_b128 v226, v[164:167] offset:0
  ds_write_b128 v226, v[168:171] offset:1024
  ds_write_b128 v226, v[172:175] offset:2048
  ds_write_b128 v226, v[176:179] offset:3072
  ds_write_b128 v228, v[180:183] offset:0
  ds_write_b128 v228, v[184:187] offset:64
  v_mov_b32 v96, 1
  s_waitcnt lgkmcnt(0)
  ds_write_b32 v229, v96 offset:0
  s_branch L_kvdone
L_kvlower:
  s_mov_b32 s83, 0
L_lp_12:
  ds_read_b32 v96, v229 offset:0
  s_waitcnt lgkmcnt(0)
  v_readfirstlane_b32 s82, v96
  s_add_u32 s83, s83, 1
  s_cmp_ge_u32 s82, 1
  s_cbranch_scc1 L_lpd_13
  s_cmp_lt_u32 s83, 3200000
  s_cbranch_scc1 L_lp_12
L_lpd_13:
  ds_read_b128 v[96:99], v226 offset:0
  ds_read_b128 v[100:103], v226 offset:1024
  ds_read_b128 v[104:107], v226 offset:2048
  ds_read_b128 v[108:111], v226 offset:3072
  ds_read_b128 v[112:115], v228 offset:0
  ds_read_b128 v[116:119], v228 offset:64
  s_lshl_b32 s81, s65, 5
  s_add_u32 s81, s81, s80
  s_lshl_b32 s82, s81, 11
  s_add_u32 s82, s82, 0xc00000
  s_lshl_b32 s83, s81, 7
  s_add_u32 s83, s83, 0xe00000
  s_waitcnt lgkmcnt(0)
  v_add_f32 v164, v164, v96
  v_add_f32 v165, v165, v97
  v_add_f32 v166, v166, v98
  v_add_f32 v167, v167, v99
  v_add_f32 v168, v168, v100
  v_add_f32 v169, v169, v101
  v_add_f32 v170, v170, v102
  v_add_f32 v171, v171, v103
  v_add_f32 v172, v172, v104
  v_add_f32 v173, v173, v105
  v_add_f32 v174, v174, v106
  v_add_f32 v175, v175, v107
  v_add_f32 v176, v176, v108
  v_add_f32 v177, v177, v109
  v_add_f32 v178, v178, v110
  v_add_f32 v179, v179, v111
  v_add_f32 v180, v180, v112
  v_add_f32 v181, v181, v113
  v_add_f32 v182, v182, v114
  v_add_f32 v183, v183, v115
  v_add_f32 v184, v184, v116
  v_add_f32 v185, v185, v117
  v_add_f32 v186, v186, v118
  v_add_f32 v187, v187, v119
  v_cvt_pk_bf16_f32 v96, v164, v165
  v_cvt_pk_bf16_f32 v97, v166, v167
  v_cvt_pk_bf16_f32 v98, v172, v173
  v_cvt_pk_bf16_f32 v99, v174, v175
  buffer_store_dwordx4 v[96:99], v224, s[44:47], s82 offen offset:0 sc1
  v_cvt_pk_bf16_f32 v100, v168, v169
  v_cvt_pk_bf16_f32 v101, v170, v171
  v_cvt_pk_bf16_f32 v102, v176, v177
  v_cvt_pk_bf16_f32 v103, v178, v179
  buffer_store_dwordx4 v[100:103], v224, s[44:47], s82 offen offset:1024 sc1
  v_and_b32 v120, 15, v250
  v_cmp_eq_u32 vcc, 0, v120
  s_and_saveexec_b64 s[78:79], vcc
  buffer_store_dwordx4 v[180:183], v227, s[44:47], s83 offen offset:0 sc1
  buffer_store_dwordx4 v[184:187], v227, s[44:47], s83 offen offset:64 sc1
  s_mov_b64 exec, s[78:79]
L_kvdone:
  v_mul_f32 v112, s8, v0
  v_mul_f32 v113, s8, v1
  v_mul_f32 v114, s8, v2
  v_mul_f32 v115, s8, v3
  v_mul_f32 v116, s8, v4
  v_mul_f32 v117, s8, v5
  v_mul_f32 v118, s8, v6
  v_mul_f32 v119, s8, v7
  v_mul_f32 v120, s8, v8
  v_mul_f32 v121, s8, v9
  v_mul_f32 v122, s8, v10
  v_mul_f32 v123, s8, v11
  v_mul_f32 v124, s8, v12
  v_mul_f32 v125, s8, v13
  v_mul_f32 v126, s8, v14
  v_mul_f32 v127, s8, v15
  v_exp_f32 v112, v112 clamp
  v_exp_f32 v113, v113 clamp
  v_exp_f32 v114, v114 clamp
  v_exp_f32 v115, v115 clamp
  v_exp_f32 v116, v116 clamp
  v_exp_f32 v117, v117 clamp
  v_exp_f32 v118, v118 clamp
  v_exp_f32 v119, v119 clamp
  v_exp_f32 v120, v120 clamp
  v_exp_f32 v121, v121 clamp
  v_exp_f32 v122, v122 clamp
  v_exp_f32 v123, v123 clamp
  v_exp_f32 v124, v124 clamp
  v_exp_f32 v125, v125 clamp
  v_exp_f32 v126, v126 clamp
  v_exp_f32 v127, v127 clamp
  v_add_f32 v0, 1.0, v0
  v_add_f32 v1, 1.0, v1
  v_add_f32 v2, 1.0, v2
  v_add_f32 v3, 1.0, v3
  v_add_f32 v4, 1.0, v4
  v_add_f32 v5, 1.0, v5
  v_add_f32 v6, 1.0, v6
  v_add_f32 v7, 1.0, v7
  v_add_f32 v8, 1.0, v8
  v_add_f32 v9, 1.0, v9
  v_add_f32 v10, 1.0, v10
  v_add_f32 v11, 1.0, v11
  v_add_f32 v12, 1.0, v12
  v_add_f32 v13, 1.0, v13
  v_add_f32 v14, 1.0, v14
  v_add_f32 v15, 1.0, v15
  v_max_f32 v0, v0, v112
  v_max_f32 v1, v1, v113
  v_max_f32 v2, v2, v114
  v_max_f32 v3, v3, v115
  v_max_f32 v4, v4, v116
  v_max_f32 v5, v5, v117
  v_max_f32 v6, v6, v118
  v_max_f32 v7, v7, v119
  v_max_f32 v8, v8, v120
  v_max_f32 v9, v9, v121
  v_max_f32 v10, v10, v122
  v_max_f32 v11, v11, v123
  v_max_f32 v12, v12, v124
  v_max_f32 v13, v13, v125
  v_max_f32 v14, v14, v126
  v_max_f32 v15, v15, v127
  v_add_f32 v0, s10, v0
  v_add_f32 v1, s10, v1
  v_add_f32 v2, s10, v2
  v_add_f32 v3, s10, v3
  v_add_f32 v4, s10, v4
  v_add_f32 v5, s10, v5
  v_add_f32 v6, s10, v6
  v_add_f32 v7, s10, v7
  v_add_f32 v8, s10, v8
  v_add_f32 v9, s10, v9
  v_add_f32 v10, s10, v10
  v_add_f32 v11, s10, v11
  v_add_f32 v12, s10, v12
  v_add_f32 v13, s10, v13
  v_add_f32 v14, s10, v14
  v_add_f32 v15, s10, v15
  s_cmp_eq_u32 s72, 0
  s_cbranch_scc0 L_kvsig_done
  s_lshl_b32 s82, s66, 4
  s_add_u32 s82, s82, s65
  s_lshl_b32 s82, s82, 8
  s_add_u32 s82, s82, 0xf10000
  s_lshl_b32 s83, s71, 2
  v_mov_b32 v96, s68
  v_mov_b32 v97, s83
  s_waitcnt vmcnt(0)
  s_mov_b64 exec, 1
  buffer_store_dword v96, v97, s[44:47], s82 offen sc1
  s_mov_b64 exec, -1
L_kvsig_done:
  v_mul_f32 v112, s8, v16
  v_mul_f32 v113, s8, v17
  v_mul_f32 v114, s8, v18
  v_mul_f32 v115, s8, v19
  v_mul_f32 v116, s8, v20
  v_mul_f32 v117, s8, v21
  v_mul_f32 v118, s8, v22
  v_mul_f32 v119, s8, v23
  v_mul_f32 v120, s8, v24
  v_mul_f32 v121, s8, v25
  v_mul_f32 v122, s8, v26
  v_mul_f32 v123, s8, v27
  v_mul_f32 v124, s8, v28
  v_mul_f32 v125, s8, v29
  v_mul_f32 v126, s8, v30
  v_mul_f32 v127, s8, v31
  v_exp_f32 v112, v112 clamp
  v_exp_f32 v113, v113 clamp
  v_exp_f32 v114, v114 clamp
  v_exp_f32 v115, v115 clamp
  v_exp_f32 v116, v116 clamp
  v_exp_f32 v117, v117 clamp
  v_exp_f32 v118, v118 clamp
  v_exp_f32 v119, v119 clamp
  v_exp_f32 v120, v120 clamp
  v_exp_f32 v121, v121 clamp
  v_exp_f32 v122, v122 clamp
  v_exp_f32 v123, v123 clamp
  v_exp_f32 v124, v124 clamp
  v_exp_f32 v125, v125 clamp
  v_exp_f32 v126, v126 clamp
  v_exp_f32 v127, v127 clamp
  v_add_f32 v16, 1.0, v16
  v_add_f32 v17, 1.0, v17
  v_add_f32 v18, 1.0, v18
  v_add_f32 v19, 1.0, v19
  v_add_f32 v20, 1.0, v20
  v_add_f32 v21, 1.0, v21
  v_add_f32 v22, 1.0, v22
  v_add_f32 v23, 1.0, v23
  v_add_f32 v24, 1.0, v24
  v_add_f32 v25, 1.0, v25
  v_add_f32 v26, 1.0, v26
  v_add_f32 v27, 1.0, v27
  v_add_f32 v28, 1.0, v28
  v_add_f32 v29, 1.0, v29
  v_add_f32 v30, 1.0, v30
  v_add_f32 v31, 1.0, v31
  v_max_f32 v16, v16, v112
  v_max_f32 v17, v17, v113
  v_max_f32 v18, v18, v114
  v_max_f32 v19, v19, v115
  v_max_f32 v20, v20, v116
  v_max_f32 v21, v21, v117
  v_max_f32 v22, v22, v118
  v_max_f32 v23, v23, v119
  v_max_f32 v24, v24, v120
  v_max_f32 v25, v25, v121
  v_max_f32 v26, v26, v122
  v_max_f32 v27, v27, v123
  v_max_f32 v28, v28, v124
  v_max_f32 v29, v29, v125
  v_max_f32 v30, v30, v126
  v_max_f32 v31, v31, v127
  v_add_f32 v16, s10, v16
  v_add_f32 v17, s10, v17
  v_add_f32 v18, s10, v18
  v_add_f32 v19, s10, v19
  v_add_f32 v20, s10, v20
  v_add_f32 v21, s10, v21
  v_add_f32 v22, s10, v22
  v_add_f32 v23, s10, v23
  v_add_f32 v24, s10, v24
  v_add_f32 v25, s10, v25
  v_add_f32 v26, s10, v26
  v_add_f32 v27, s10, v27
  v_add_f32 v28, s10, v28
  v_add_f32 v29, s10, v29
  v_add_f32 v30, s10, v30
  v_add_f32 v31, s10, v31
  v_cvt_pk_bf16_f32 v32, v0, v1
  v_cvt_pk_bf16_f32 v33, v2, v3
  v_cvt_pk_bf16_f32 v34, v16, v17
  v_cvt_pk_bf16_f32 v35, v18, v19
  v_cvt_pk_bf16_f32 v36, v4, v5
  v_cvt_pk_bf16_f32 v37, v6, v7
  v_cvt_pk_bf16_f32 v38, v20, v21
  v_cvt_pk_bf16_f32 v39, v22, v23
  v_cvt_pk_bf16_f32 v40, v8, v9
  v_cvt_pk_bf16_f32 v41, v10, v11
  v_cvt_pk_bf16_f32 v42, v24, v25
  v_cvt_pk_bf16_f32 v43, v26, v27
  v_cvt_pk_bf16_f32 v44, v12, v13
  v_cvt_pk_bf16_f32 v45, v14, v15
  v_cvt_pk_bf16_f32 v46, v28, v29
  v_cvt_pk_bf16_f32 v47, v30, v31
  s_mov_b32 s48, s16
  s_and_b32 s49, s17, 0xffff
  s_mov_b32 s50, 0x400000
  s_mov_b32 s51, 0x20000
  s_mov_b32 s52, s36
  s_and_b32 s53, s37, 0xffff
  s_mov_b32 s54, 0x400000
  s_mov_b32 s55, 0x20000
  v_lshrrev_b32 v232, 2, v250
  v_lshlrev_b32 v232, 8, v232
  v_and_b32 v233, 3, v250
  v_lshlrev_b32 v233, 2, v233
  v_add_u32 v232, v232, v233
  s_lshl_b32 s78, s43, 1
  s_add_u32 s78, s78, s71
  s_lshl_b32 s79, s78, 11
  s_lshl_b32 s80, s72, 10
  s_add_u32 s79, s79, s80
  s_add_u32 s79, s79, 0xc00000
  v_and_b32 v73, 15, v250
  v_lshlrev_b32 v73, 12, v73
  v_lshrrev_b32 v49, 4, v250
  v_lshlrev_b32 v49, 4, v49
  v_add_u32 v73, v73, v49
  s_lshl_b32 s15, s78, 7
  s_add_u32 s15, s15, 0xe00000
  s_add_u32 s81, s65, 0
  s_and_b32 s81, s81, 15
  s_lshl_b32 s81, s81, 16
  s_add_u32 s16, s81, s79
  s_add_u32 s81, s65, 1
  s_and_b32 s81, s81, 15
  s_lshl_b32 s81, s81, 16
  s_add_u32 s17, s81, s79
  s_add_u32 s81, s65, 2
  s_and_b32 s81, s81, 15
  s_lshl_b32 s81, s81, 16
  s_add_u32 s18, s81, s79
  s_add_u32 s81, s65, 3
  s_and_b32 s81, s81, 15
  s_lshl_b32 s81, s81, 16
  s_add_u32 s19, s81, s79
  s_add_u32 s81, s65, 4
  s_and_b32 s81, s81, 15
  s_lshl_b32 s81, s81, 16
  s_add_u32 s20, s81, s79
  s_add_u32 s81, s65, 5
  s_and_b32 s81, s81, 15
  s_lshl_b32 s81, s81, 16
  s_add_u32 s21, s81, s79
  s_add_u32 s81, s65, 6
  s_and_b32 s81, s81, 15
  s_lshl_b32 s81, s81, 16
  s_add_u32 s22, s81, s79
  s_add_u32 s81, s65, 7
  s_and_b32 s81, s81, 15
  s_lshl_b32 s81, s81, 16
  s_add_u32 s23, s81, s79
  s_add_u32 s81, s65, 8
  s_and_b32 s81, s81, 15
  s_lshl_b32 s81, s81, 16
  s_add_u32 s24, s81, s79
  s_add_u32 s81, s65, 9
  s_and_b32 s81, s81, 15
  s_lshl_b32 s81, s81, 16
  s_add_u32 s25, s81, s79
  s_add_u32 s81, s65, 10
  s_and_b32 s81, s81, 15
  s_lshl_b32 s81, s81, 16
  s_add_u32 s26, s81, s79
  s_add_u32 s81, s65, 11
  s_and_b32 s81, s81, 15
  s_lshl_b32 s81, s81, 16
  s_add_u32 s27, s81, s79
  s_add_u32 s81, s65, 12
  s_and_b32 s81, s81, 15
  s_lshl_b32 s81, s81, 16
  s_add_u32 s28, s81, s79
  s_add_u32 s81, s65, 13
  s_and_b32 s81, s81, 15
  s_lshl_b32 s81, s81, 16
  s_add_u32 s29, s81, s79
  s_add_u32 s81, s65, 14
  s_and_b32 s81, s81, 15
  s_lshl_b32 s81, s81, 16
  s_add_u32 s30, s81, s79
  s_add_u32 s81, s65, 15
  s_and_b32 s81, s81, 15
  s_lshl_b32 s81, s81, 16
  s_add_u32 s31, s81, s79
  v_and_b32 v50, 15, v250
  v_lshrrev_b32 v51, 2, v50
  v_lshrrev_b32 v60, 4, v250
  v_and_b32 v61, 1, v50
  v_lshlrev_b32 v61, 4, v61
  v_mov_b32 v62, 0x3f80
  v_lshlrev_b32 v62, v61, v62
  v_cmp_eq_u32 vcc, v51, v60
  v_bfe_u32 v61, v50, 1, 1
  v_mov_b32 v63, 0
  v_cndmask_b32 v62, v63, v62, vcc
  v_cmp_eq_u32 vcc, 0, v61
  v_mov_b32 v170, 0
  v_mov_b32 v171, 0
  v_cndmask_b32 v168, v63, v62, vcc
  v_cndmask_b32 v169, v62, v63, vcc
  v_mov_b32 v172, 0
  v_mov_b32 v173, 0
  v_mov_b32 v174, v168
  v_mov_b32 v175, v169
  s_lshl_b32 s78, s71, 11
  s_lshl_b32 s79, s72, 10
  s_add_u32 s78, s78, 158976
  s_add_u32 s80, s78, s79
  s_xor_b32 s79, s79, 1024
  s_add_u32 s81, s78, s79
  v_add_u32 v74, s80, v224
  v_add_u32 v75, s81, v224
  s_lshl_b32 s78, s64, 2
  s_xor_b32 s79, s78, 8
  v_add_u32 v76, s78, v230
  v_add_u32 v77, s79, v230
  v_mov_b32 v72, 1
  s_lshl_b32 s14, s65, 3
  s_lshl_b32 s79, s72, 2
  s_add_u32 s14, s14, s79
  s_lshl_b32 s14, s14, 5
  s_lshl_b32 s79, s43, 1
  s_add_u32 s14, s14, s79
  s_add_u32 s14, s14, s71
  s_lshl_b32 s14, s14, 10
  s_add_u32 s14, s14, 0x0
  s_lshl_b32 s60, s65, 4
  s_add_u32 s60, s60, s43
  s_lshl_b32 s60, s60, 8
  s_add_u32 s60, s60, 0xf20000
  s_lshl_b32 s61, s64, 2
  s_lshl_b32 s78, s43, 12
  s_add_u32 s78, s78, 0xf10000
  s_cmp_eq_u32 s64, 2
  s_cbranch_scc0 L_s2_lds
  s_mov_b32 s80, 0x33333333
  s_mov_b32 s81, 0x33333333
  s_mov_b32 s82, 0
L_poll_14:
  buffer_load_dword v234, v232, s[44:47], s78 offen sc1
  s_waitcnt vmcnt(0)
  v_cmp_eq_u32 vcc, s68, v234
  s_add_u32 s82, s82, 1
  s_and_b64 vcc, vcc, s[80:81]
  s_cmp_eq_u64 vcc, s[80:81]
  s_cbranch_scc1 L_pdone_15
  s_cmp_lt_u32 s82, 200000
  s_cbranch_scc1 L_poll_14
L_pdone_15:
  ds_write_b32 v230, v72 offset:36
  s_branch L_s2_done
L_s2_lds:
  s_mov_b32 s81, 0
L_lp_16:
  ds_read_b32 v234, v230 offset:36
  s_waitcnt lgkmcnt(0)
  v_readfirstlane_b32 s80, v234
  s_add_u32 s81, s81, 1
  s_cmp_ge_u32 s80, 1
  s_cbranch_scc1 L_lpd_17
  s_cmp_lt_u32 s81, 3200000
  s_cbranch_scc1 L_lp_16
L_lpd_17:
L_s2_done:
  buffer_load_dwordx4 v[52:55], v73, s[44:47], s15 offen sc1
  buffer_load_dwordx4 v[56:59], v73, s[44:47], s15 offen offset:64 sc1
  buffer_load_dwordx4 v[96:99], v224, s[44:47], s16 offen sc1
  buffer_load_dwordx4 v[100:103], v224, s[44:47], s17 offen sc1
  buffer_load_dwordx4 v[104:107], v224, s[44:47], s18 offen sc1
  buffer_load_dwordx4 v[108:111], v224, s[44:47], s19 offen sc1
  buffer_load_dwordx4 v[112:115], v224, s[44:47], s20 offen sc1
  buffer_load_dwordx4 v[116:119], v224, s[44:47], s21 offen sc1
  buffer_load_dwordx4 v[120:123], v224, s[44:47], s22 offen sc1
  buffer_load_dwordx4 v[124:127], v224, s[44:47], s23 offen sc1
  buffer_load_dwordx4 v[128:131], v224, s[44:47], s24 offen sc1
  buffer_load_dwordx4 v[132:135], v224, s[44:47], s25 offen sc1
  buffer_load_dwordx4 v[136:139], v224, s[44:47], s26 offen sc1
  buffer_load_dwordx4 v[140:143], v224, s[44:47], s27 offen sc1
  buffer_load_dwordx4 v[144:147], v224, s[44:47], s28 offen sc1
  buffer_load_dwordx4 v[148:151], v224, s[44:47], s29 offen sc1
  buffer_load_dwordx4 v[152:155], v224, s[44:47], s30 offen sc1
  buffer_load_dwordx4 v[156:159], v224, s[44:47], s31 offen sc1
  s_waitcnt vmcnt(16)
  v_add_f32_dpp v52, v52, v52 row_ror:8 row_mask:0xf bank_mask:0xf
  v_add_f32_dpp v53, v53, v53 row_ror:8 row_mask:0xf bank_mask:0xf
  v_add_f32_dpp v54, v54, v54 row_ror:8 row_mask:0xf bank_mask:0xf
  v_add_f32_dpp v55, v55, v55 row_ror:8 row_mask:0xf bank_mask:0xf
  v_add_f32_dpp v56, v56, v56 row_ror:8 row_mask:0xf bank_mask:0xf
  v_add_f32_dpp v57, v57, v57 row_ror:8 row_mask:0xf bank_mask:0xf
  v_add_f32_dpp v58, v58, v58 row_ror:8 row_mask:0xf bank_mask:0xf
  v_add_f32_dpp v59, v59, v59 row_ror:8 row_mask:0xf bank_mask:0xf
  v_add_f32_dpp v52, v52, v52 row_ror:4 row_mask:0xf bank_mask:0xf
  v_add_f32_dpp v53, v53, v53 row_ror:4 row_mask:0xf bank_mask:0xf
  v_add_f32_dpp v54, v54, v54 row_ror:4 row_mask:0xf bank_mask:0xf
  v_add_f32_dpp v55, v55, v55 row_ror:4 row_mask:0xf bank_mask:0xf
  v_add_f32_dpp v56, v56, v56 row_ror:4 row_mask:0xf bank_mask:0xf
  v_add_f32_dpp v57, v57, v57 row_ror:4 row_mask:0xf bank_mask:0xf
  v_add_f32_dpp v58, v58, v58 row_ror:4 row_mask:0xf bank_mask:0xf
  v_add_f32_dpp v59, v59, v59 row_ror:4 row_mask:0xf bank_mask:0xf
  v_add_f32_dpp v52, v52, v52 row_ror:2 row_mask:0xf bank_mask:0xf
  v_add_f32_dpp v53, v53, v53 row_ror:2 row_mask:0xf bank_mask:0xf
  v_add_f32_dpp v54, v54, v54 row_ror:2 row_mask:0xf bank_mask:0xf
  v_add_f32_dpp v55, v55, v55 row_ror:2 row_mask:0xf bank_mask:0xf
  v_add_f32_dpp v56, v56, v56 row_ror:2 row_mask:0xf bank_mask:0xf
  v_add_f32_dpp v57, v57, v57 row_ror:2 row_mask:0xf bank_mask:0xf
  v_add_f32_dpp v58, v58, v58 row_ror:2 row_mask:0xf bank_mask:0xf
  v_add_f32_dpp v59, v59, v59 row_ror:2 row_mask:0xf bank_mask:0xf
  v_add_f32_dpp v52, v52, v52 row_ror:1 row_mask:0xf bank_mask:0xf
  v_add_f32_dpp v53, v53, v53 row_ror:1 row_mask:0xf bank_mask:0xf
  v_add_f32_dpp v54, v54, v54 row_ror:1 row_mask:0xf bank_mask:0xf
  v_add_f32_dpp v55, v55, v55 row_ror:1 row_mask:0xf bank_mask:0xf
  v_add_f32_dpp v56, v56, v56 row_ror:1 row_mask:0xf bank_mask:0xf
  v_add_f32_dpp v57, v57, v57 row_ror:1 row_mask:0xf bank_mask:0xf
  v_add_f32_dpp v58, v58, v58 row_ror:1 row_mask:0xf bank_mask:0xf
  v_add_f32_dpp v59, v59, v59 row_ror:1 row_mask:0xf bank_mask:0xf
  v_cvt_pk_bf16_f32 v60, v52, v53
  v_cvt_pk_bf16_f32 v61, v54, v55
  v_cvt_pk_bf16_f32 v62, v56, v57
  v_cvt_pk_bf16_f32 v63, v58, v59
  s_waitcnt vmcnt(14)
  v_mfma_f32_16x16x32_bf16 v[160:163], v[168:171], v[96:99], 0
  v_mfma_f32_16x16x32_bf16 v[164:167], v[172:175], v[96:99], 0
  v_mfma_f32_16x16x32_bf16 v[160:163], v[168:171], v[100:103], v[160:163]
  v_mfma_f32_16x16x32_bf16 v[164:167], v[172:175], v[100:103], v[164:167]
  s_waitcnt vmcnt(12)
  v_mfma_f32_16x16x32_bf16 v[160:163], v[168:171], v[104:107], v[160:163]
  v_mfma_f32_16x16x32_bf16 v[164:167], v[172:175], v[104:107], v[164:167]
  v_mfma_f32_16x16x32_bf16 v[160:163], v[168:171], v[108:111], v[160:163]
  v_mfma_f32_16x16x32_bf16 v[164:167], v[172:175], v[108:111], v[164:167]
  s_waitcnt vmcnt(10)
  v_mfma_f32_16x16x32_bf16 v[160:163], v[168:171], v[112:115], v[160:163]
  v_mfma_f32_16x16x32_bf16 v[164:167], v[172:175], v[112:115], v[164:167]
  v_mfma_f32_16x16x32_bf16 v[160:163], v[168:171], v[116:119], v[160:163]
  v_mfma_f32_16x16x32_bf16 v[164:167], v[172:175], v[116:119], v[164:167]
  s_waitcnt vmcnt(8)
  v_mfma_f32_16x16x32_bf16 v[160:163], v[168:171], v[120:123], v[160:163]
  v_mfma_f32_16x16x32_bf16 v[164:167], v[172:175], v[120:123], v[164:167]
  v_mfma_f32_16x16x32_bf16 v[160:163], v[168:171], v[124:127], v[160:163]
  v_mfma_f32_16x16x32_bf16 v[164:167], v[172:175], v[124:127], v[164:167]
  s_waitcnt vmcnt(6)
  v_mfma_f32_16x16x32_bf16 v[160:163], v[168:171], v[128:131], v[160:163]
  v_mfma_f32_16x16x32_bf16 v[164:167], v[172:175], v[128:131], v[164:167]
  v_mfma_f32_16x16x32_bf16 v[160:163], v[168:171], v[132:135], v[160:163]
  v_mfma_f32_16x16x32_bf16 v[164:167], v[172:175], v[132:135], v[164:167]
  s_waitcnt vmcnt(4)
  v_mfma_f32_16x16x32_bf16 v[160:163], v[168:171], v[136:139], v[160:163]
  v_mfma_f32_16x16x32_bf16 v[164:167], v[172:175], v[136:139], v[164:167]
  v_mfma_f32_16x16x32_bf16 v[160:163], v[168:171], v[140:143], v[160:163]
  v_mfma_f32_16x16x32_bf16 v[164:167], v[172:175], v[140:143], v[164:167]
  s_waitcnt vmcnt(2)
  v_mfma_f32_16x16x32_bf16 v[160:163], v[168:171], v[144:147], v[160:163]
  v_mfma_f32_16x16x32_bf16 v[164:167], v[172:175], v[144:147], v[164:167]
  v_mfma_f32_16x16x32_bf16 v[160:163], v[168:171], v[148:151], v[160:163]
  v_mfma_f32_16x16x32_bf16 v[164:167], v[172:175], v[148:151], v[164:167]
  s_waitcnt vmcnt(0)
  v_mfma_f32_16x16x32_bf16 v[160:163], v[168:171], v[152:155], v[160:163]
  v_mfma_f32_16x16x32_bf16 v[164:167], v[172:175], v[152:155], v[164:167]
  v_mfma_f32_16x16x32_bf16 v[160:163], v[168:171], v[156:159], v[160:163]
  v_mfma_f32_16x16x32_bf16 v[164:167], v[172:175], v[156:159], v[164:167]
  s_nop 7
  v_cvt_pk_bf16_f32 v64, v160, v161
  v_cvt_pk_bf16_f32 v65, v162, v163
  v_cvt_pk_bf16_f32 v66, v164, v165
  v_cvt_pk_bf16_f32 v67, v166, v167
  ds_write_b128 v74, v[64:67]
  s_waitcnt lgkmcnt(0)
  ds_write_b32 v76, v72 offset:8
  s_mov_b32 s83, 0
L_lp_18:
  ds_read_b32 v48, v77 offset:8
  s_waitcnt lgkmcnt(0)
  v_readfirstlane_b32 s82, v48
  s_add_u32 s83, s83, 1
  s_cmp_ge_u32 s82, 1
  s_cbranch_scc1 L_lpd_19
  s_cmp_lt_u32 s83, 3200000
  s_cbranch_scc1 L_lp_18
L_lpd_19:
  ds_read_b128 v[68:71], v75
  s_waitcnt lgkmcnt(0)
  s_cmp_eq_u32 s72, 0
  s_cbranch_scc1 L_noswap
  v_swap_b32 v64, v68
  v_swap_b32 v65, v69
  v_swap_b32 v66, v70
  v_swap_b32 v67, v71
L_noswap:
  s_nop 1
  v_mfma_f32_16x16x32_bf16 v[128:131], v[60:63], v[32:35], 0
  v_mfma_f32_16x16x32_bf16 v[132:135], v[60:63], v[36:39], 0
  v_mfma_f32_16x16x32_bf16 v[136:139], v[60:63], v[40:43], 0
  v_mfma_f32_16x16x32_bf16 v[140:143], v[60:63], v[44:47], 0
  v_mfma_f32_16x16x32_bf16 v[96:99], v[64:67], v[32:35], 0
  v_mfma_f32_16x16x32_bf16 v[112:115], v[68:71], v[32:35], 0
  v_mfma_f32_16x16x32_bf16 v[100:103], v[64:67], v[36:39], 0
  v_mfma_f32_16x16x32_bf16 v[116:119], v[68:71], v[36:39], 0
  v_mfma_f32_16x16x32_bf16 v[104:107], v[64:67], v[40:43], 0
  v_mfma_f32_16x16x32_bf16 v[120:123], v[68:71], v[40:43], 0
  v_mfma_f32_16x16x32_bf16 v[108:111], v[64:67], v[44:47], 0
  v_mfma_f32_16x16x32_bf16 v[124:127], v[68:71], v[44:47], 0
  v_add_f32 v128, s10, v128
  v_add_f32 v132, s10, v132
  v_add_f32 v136, s10, v136
  v_add_f32 v140, s10, v140
  v_rcp_f32 v128, v128
  v_rcp_f32 v132, v132
  v_rcp_f32 v136, v136
  v_rcp_f32 v140, v140
  v_mul_f32 v96, v96, v128
  v_mul_f32 v97, v97, v128
  v_mul_f32 v98, v98, v128
  v_mul_f32 v99, v99, v128
  v_mul_f32 v112, v112, v128
  v_mul_f32 v113, v113, v128
  v_mul_f32 v114, v114, v128
  v_mul_f32 v115, v115, v128
  v_cvt_pk_bf16_f32 v144, v96, v97
  v_cvt_pk_bf16_f32 v145, v98, v99
  v_cvt_pk_bf16_f32 v146, v112, v113
  v_cvt_pk_bf16_f32 v147, v114, v115
  s_add_u32 s79, s14, 0
  buffer_store_dwordx4 v[144:147], v224, s[44:47], s79 offen sc1
  v_mul_f32 v100, v100, v132
  v_mul_f32 v101, v101, v132
  v_mul_f32 v102, v102, v132
  v_mul_f32 v103, v103, v132
  v_mul_f32 v116, v116, v132
  v_mul_f32 v117, v117, v132
  v_mul_f32 v118, v118, v132
  v_mul_f32 v119, v119, v132
  v_cvt_pk_bf16_f32 v148, v100, v101
  v_cvt_pk_bf16_f32 v149, v102, v103
  v_cvt_pk_bf16_f32 v150, v116, v117
  v_cvt_pk_bf16_f32 v151, v118, v119
  s_add_u32 s79, s14, 32768
  buffer_store_dwordx4 v[148:151], v224, s[44:47], s79 offen sc1
  v_mul_f32 v104, v104, v136
  v_mul_f32 v105, v105, v136
  v_mul_f32 v106, v106, v136
  v_mul_f32 v107, v107, v136
  v_mul_f32 v120, v120, v136
  v_mul_f32 v121, v121, v136
  v_mul_f32 v122, v122, v136
  v_mul_f32 v123, v123, v136
  v_cvt_pk_bf16_f32 v152, v104, v105
  v_cvt_pk_bf16_f32 v153, v106, v107
  v_cvt_pk_bf16_f32 v154, v120, v121
  v_cvt_pk_bf16_f32 v155, v122, v123
  s_add_u32 s79, s14, 65536
  buffer_store_dwordx4 v[152:155], v224, s[44:47], s79 offen sc1
  v_mul_f32 v108, v108, v140
  v_mul_f32 v109, v109, v140
  v_mul_f32 v110, v110, v140
  v_mul_f32 v111, v111, v140
  v_mul_f32 v124, v124, v140
  v_mul_f32 v125, v125, v140
  v_mul_f32 v126, v126, v140
  v_mul_f32 v127, v127, v140
  v_cvt_pk_bf16_f32 v156, v108, v109
  v_cvt_pk_bf16_f32 v157, v110, v111
  v_cvt_pk_bf16_f32 v158, v124, v125
  v_cvt_pk_bf16_f32 v159, v126, v127
  s_add_u32 s79, s14, 98304
  buffer_store_dwordx4 v[156:159], v224, s[44:47], s79 offen sc1
  v_mov_b32 v96, s68
  v_mov_b32 v97, s61
  s_waitcnt vmcnt(0)
  s_mov_b64 exec, 1
  buffer_store_dword v96, v97, s[44:47], s60 offen sc1
  s_mov_b64 exec, -1
  v_and_b32 v1, 15, v250
  v_lshrrev_b32 v2, 4, v250
  s_lshl_b32 s73, s69, 7
  s_lshl_b32 s74, s64, 5
  s_add_u32 s73, s73, s74
  v_add_u32 v3, s73, v1
  v_lshlrev_b32 v4, 11, v3
  v_lshlrev_b32 v5, 4, v2
  v_add_u32 v4, v4, v5
  s_lshl_b32 s74, s70, 7
  v_add_u32 v192, s74, v4
  v_add_u32 v193, 0x8000, v192
  v_lshlrev_b32 v3, 2, v3
  s_mov_b32 s75, 0xe80000
  buffer_load_dwordx4 v[128:131], v192, s[48:51], 0 offen offset:0
  buffer_load_dwordx4 v[132:135], v192, s[48:51], 0 offen offset:64
  buffer_load_dwordx4 v[136:139], v193, s[48:51], 0 offen offset:0
  buffer_load_dwordx4 v[140:143], v193, s[48:51], 0 offen offset:64
  s_lshl_b32 s76, s69, 12
  s_add_u32 s76, s76, 0xf40000
  s_mov_b32 s80, 0x33333333
  s_mov_b32 s81, 0x33333333
  s_mov_b32 s82, 0
L_poll_20:
  buffer_load_dword v234, v232, s[44:47], s76 offen sc1
  s_waitcnt vmcnt(0)
  v_cmp_eq_u32 vcc, s68, v234
  s_add_u32 s82, s82, 1
  s_and_b64 vcc, vcc, s[80:81]
  s_cmp_eq_u64 vcc, s[80:81]
  s_cbranch_scc1 L_pdone_21
  s_cmp_lt_u32 s82, 200000
  s_cbranch_scc1 L_poll_20
L_pdone_21:
  buffer_load_dword v144, v3, s[44:47], s75 offen sc1
  buffer_load_dword v145, v3, s[44:47], s75 offen offset:64 sc1
  v_bfe_u32 v3, v250, 2, 2
  v_lshlrev_b32 v4, 2, v2
  v_add_u32 v4, v4, v3
  v_lshlrev_b32 v5, 7, v4
  v_lshrrev_b32 v4, 1, v4
  v_and_b32 v4, 3, v4
  v_lshlrev_b32 v4, 1, v4
  v_bfe_u32 v6, v250, 1, 1
  v_and_b32 v7, 1, v250
  v_lshlrev_b32 v7, 3, v7
  v_add_u32 v5, v5, v7
  v_or_b32 v7, 0, v6
  v_xor_b32 v7, v7, v4
  v_lshlrev_b32 v7, 4, v7
  v_add_u32 v148, v5, v7
  v_or_b32 v7, 2, v6
  v_xor_b32 v7, v7, v4
  v_lshlrev_b32 v7, 4, v7
  v_add_u32 v149, v5, v7
  v_or_b32 v7, 4, v6
  v_xor_b32 v7, v7, v4
  v_lshlrev_b32 v7, 4, v7
  v_add_u32 v150, v5, v7
  v_or_b32 v7, 6, v6
  v_xor_b32 v7, v7, v4
  v_lshlrev_b32 v7, 4, v7
  v_add_u32 v151, v5, v7
  s_and_b32 s76, s70, 7
  s_mul_i32 s76, s76, 3
  s_lshr_b32 s76, s76, 1
  s_add_u32 s77, s76, 0
  s_cmp_ge_u32 s77, 12
  s_cselect_b32 s79, 12, 0
  s_sub_u32 s77, s77, s79
  s_mul_i32 s79, s77, 11
  s_lshr_b32 s79, s79, 5
  s_add_u32 s77, s77, s79
  s_lshl_b32 s4, s77, 11
  s_add_u32 s77, s76, 1
  s_cmp_ge_u32 s77, 12
  s_cselect_b32 s79, 12, 0
  s_sub_u32 s77, s77, s79
  s_mul_i32 s79, s77, 11
  s_lshr_b32 s79, s79, 5
  s_add_u32 s77, s77, s79
  s_lshl_b32 s5, s77, 11
  s_add_u32 s77, s76, 2
  s_cmp_ge_u32 s77, 12
  s_cselect_b32 s79, 12, 0
  s_sub_u32 s77, s77, s79
  s_mul_i32 s79, s77, 11
  s_lshr_b32 s79, s79, 5
  s_add_u32 s77, s77, s79
  s_lshl_b32 s6, s77, 11
  s_add_u32 s77, s76, 3
  s_cmp_ge_u32 s77, 12
  s_cselect_b32 s79, 12, 0
  s_sub_u32 s77, s77, s79
  s_mul_i32 s79, s77, 11
  s_lshr_b32 s79, s79, 5
  s_add_u32 s77, s77, s79
  s_lshl_b32 s7, s77, 11
  s_add_u32 s77, s76, 4
  s_cmp_ge_u32 s77, 12
  s_cselect_b32 s79, 12, 0
  s_sub_u32 s77, s77, s79
  s_mul_i32 s79, s77, 11
  s_lshr_b32 s79, s79, 5
  s_add_u32 s77, s77, s79
  s_lshl_b32 s8, s77, 11
  s_add_u32 s77, s76, 5
  s_cmp_ge_u32 s77, 12
  s_cselect_b32 s79, 12, 0
  s_sub_u32 s77, s77, s79
  s_mul_i32 s79, s77, 11
  s_lshr_b32 s79, s79, 5
  s_add_u32 s77, s77, s79
  s_lshl_b32 s9, s77, 11
  s_add_u32 s77, s76, 6
  s_cmp_ge_u32 s77, 12
  s_cselect_b32 s79, 12, 0
  s_sub_u32 s77, s77, s79
  s_mul_i32 s79, s77, 11
  s_lshr_b32 s79, s79, 5
  s_add_u32 s77, s77, s79
  s_lshl_b32 s10, s77, 11
  s_add_u32 s77, s76, 7
  s_cmp_ge_u32 s77, 12
  s_cselect_b32 s79, 12, 0
  s_sub_u32 s77, s77, s79
  s_mul_i32 s79, s77, 11
  s_lshr_b32 s79, s79, 5
  s_add_u32 s77, s77, s79
  s_lshl_b32 s11, s77, 11
  s_add_u32 s77, s76, 8
  s_cmp_ge_u32 s77, 12
  s_cselect_b32 s79, 12, 0
  s_sub_u32 s77, s77, s79
  s_mul_i32 s79, s77, 11
  s_lshr_b32 s79, s79, 5
  s_add_u32 s77, s77, s79
  s_lshl_b32 s12, s77, 11
  s_add_u32 s77, s76, 9
  s_cmp_ge_u32 s77, 12
  s_cselect_b32 s79, 12, 0
  s_sub_u32 s77, s77, s79
  s_mul_i32 s79, s77, 11
  s_lshr_b32 s79, s79, 5
  s_add_u32 s77, s77, s79
  s_lshl_b32 s13, s77, 11
  s_add_u32 s77, s76, 10
  s_cmp_ge_u32 s77, 12
  s_cselect_b32 s79, 12, 0
  s_sub_u32 s77, s77, s79
  s_mul_i32 s79, s77, 11
  s_lshr_b32 s79, s79, 5
  s_add_u32 s77, s77, s79
  s_lshl_b32 s14, s77, 11
  s_add_u32 s77, s76, 11
  s_cmp_ge_u32 s77, 12
  s_cselect_b32 s79, 12, 0
  s_sub_u32 s77, s77, s79
  s_mul_i32 s79, s77, 11
  s_lshr_b32 s79, s79, 5
  s_add_u32 s77, s77, s79
  s_lshl_b32 s15, s77, 11
  s_add_u32 s77, s70, 0
  s_and_b32 s77, s77, 3
  s_lshl_b32 s77, s77, 13
  s_add_u32 s56, s77, 6144
  s_add_u32 s77, s70, 1
  s_and_b32 s77, s77, 3
  s_lshl_b32 s77, s77, 13
  s_add_u32 s57, s77, 6144
  s_add_u32 s77, s70, 2
  s_and_b32 s77, s77, 3
  s_lshl_b32 s77, s77, 13
  s_add_u32 s58, s77, 6144
  s_add_u32 s77, s70, 3
  s_and_b32 s77, s77, 3
  s_lshl_b32 s77, s77, 13
  s_add_u32 s59, s77, 6144
  s_lshl_b32 s78, s69, 12
  s_add_u32 s78, s78, 0xf20000
  s_mov_b64 s[16:17], 0
  s_lshr_b32 s76, s4, 9
  s_lshl_b64 s[80:81], 15, s76
  s_or_b64 s[16:17], s[16:17], s[80:81]
  s_lshr_b32 s76, s5, 9
  s_lshl_b64 s[80:81], 15, s76
  s_or_b64 s[16:17], s[16:17], s[80:81]
  s_lshr_b32 s76, s6, 9
  s_lshl_b64 s[80:81], 15, s76
  s_or_b64 s[16:17], s[16:17], s[80:81]
  s_lshr_b32 s76, s7, 9
  s_lshl_b64 s[80:81], 15, s76
  s_or_b64 s[16:17], s[16:17], s[80:81]
  s_mov_b64 s[18:19], 0
  s_lshr_b32 s76, s8, 9
  s_lshl_b64 s[80:81], 15, s76
  s_or_b64 s[18:19], s[18:19], s[80:81]
  s_lshr_b32 s76, s9, 9
  s_lshl_b64 s[80:81], 15, s76
  s_or_b64 s[18:19], s[18:19], s[80:81]
  s_lshr_b32 s76, s10, 9
  s_lshl_b64 s[80:81], 15, s76
  s_or_b64 s[18:19], s[18:19], s[80:81]
  s_lshr_b32 s76, s11, 9
  s_lshl_b64 s[80:81], 15, s76
  s_or_b64 s[18:19], s[18:19], s[80:81]
  s_mov_b64 s[20:21], 0
  s_lshr_b32 s76, s12, 9
  s_lshl_b64 s[80:81], 15, s76
  s_or_b64 s[20:21], s[20:21], s[80:81]
  s_lshr_b32 s76, s13, 9
  s_lshl_b64 s[80:81], 15, s76
  s_or_b64 s[20:21], s[20:21], s[80:81]
  s_lshr_b32 s76, s14, 9
  s_lshl_b64 s[80:81], 15, s76
  s_or_b64 s[20:21], s[20:21], s[80:81]
  s_lshr_b32 s76, s15, 9
  s_lshl_b64 s[80:81], 15, s76
  s_or_b64 s[20:21], s[20:21], s[80:81]
  s_mov_b64 s[22:23], 0
  s_lshr_b32 s76, s56, 9
  s_lshl_b64 s[80:81], 15, s76
  s_or_b64 s[22:23], s[22:23], s[80:81]
  s_lshr_b32 s76, s57, 9
  s_lshl_b64 s[80:81], 15, s76
  s_or_b64 s[22:23], s[22:23], s[80:81]
  s_lshr_b32 s76, s58, 9
  s_lshl_b64 s[80:81], 15, s76
  s_or_b64 s[22:23], s[22:23], s[80:81]
  s_lshr_b32 s76, s59, 9
  s_lshl_b64 s[80:81], 15, s76
  s_or_b64 s[22:23], s[22:23], s[80:81]
  s_mov_b32 s82, 0
L_pm_22:
  buffer_load_dword v234, v232, s[44:47], s78 offen sc1
  s_waitcnt vmcnt(0)
  v_cmp_eq_u32 vcc, s68, v234
  s_add_u32 s82, s82, 1
  s_and_b64 vcc, vcc, s[16:17]
  s_cmp_eq_u64 vcc, s[16:17]
  s_cbranch_scc1 L_pmd_23
  s_cmp_lt_u32 s82, 200000
  s_cbranch_scc1 L_pm_22
L_pmd_23:
  s_lshl_b32 s73, s69, 3
  s_lshl_b32 s74, s64, 1
  s_add_u32 s73, s73, s74
  s_lshl_b32 s73, s73, 15
  s_add_u32 s73, s73, 0x0
  s_add_u32 s74, s73, 32768
  v_add_u32 v152, 66560, v148
  v_add_u32 v153, 66560, v149
  v_add_u32 v154, 66560, v150
  v_add_u32 v155, 66560, v151
  v_add_u32 v195, 32768, v224
  v_mov_b32 v194, v224
  v_and_b32 v196, 15, v250
  v_lshlrev_b32 v196, 7, v196
  v_lshrrev_b32 v200, 4, v250
  s_add_u32 s60, s73, s4
  buffer_load_dwordx4 v[32:35], v194, s[44:47], s60 offen offset:0 sc1
  buffer_load_dwordx4 v[36:39], v195, s[44:47], s60 offen offset:0 sc1
  buffer_load_dwordx4 v[40:43], v194, s[44:47], s60 offen offset:1024 sc1
  buffer_load_dwordx4 v[44:47], v195, s[44:47], s60 offen offset:1024 sc1
  s_add_u32 s61, s73, s5
  buffer_load_dwordx4 v[48:51], v194, s[44:47], s61 offen offset:0 sc1
  buffer_load_dwordx4 v[52:55], v195, s[44:47], s61 offen offset:0 sc1
  buffer_load_dwordx4 v[56:59], v194, s[44:47], s61 offen offset:1024 sc1
  buffer_load_dwordx4 v[60:63], v195, s[44:47], s61 offen offset:1024 sc1
  s_mov_b32 s81, 0
L_lp_24:
  ds_read_b32 v237, v230 offset:44
  s_waitcnt lgkmcnt(0)
  v_readfirstlane_b32 s80, v237
  s_add_u32 s81, s81, 1
  s_cmp_ge_u32 s80, 4
  s_cbranch_scc1 L_lpd_25
  s_cmp_lt_u32 s81, 3200000
  s_cbranch_scc1 L_lp_24
L_lpd_25:
  ds_read_b64_tr_b16 v[96:97], v152 offset:0
  ds_read_b64_tr_b16 v[98:99], v152 offset:2048
  ds_read_b64_tr_b16 v[100:101], v153 offset:0
  ds_read_b64_tr_b16 v[102:103], v153 offset:2048
  ds_read_b64_tr_b16 v[104:105], v154 offset:0
  ds_read_b64_tr_b16 v[106:107], v154 offset:2048
  ds_read_b64_tr_b16 v[108:109], v155 offset:0
  ds_read_b64_tr_b16 v[110:111], v155 offset:2048
  v_permlane16_swap_b32 v128, v130
  v_permlane16_swap_b32 v129, v131
  v_permlane16_swap_b32 v132, v134
  v_permlane16_swap_b32 v133, v135
  v_permlane16_swap_b32 v136, v138
  v_permlane16_swap_b32 v137, v139
  v_permlane16_swap_b32 v140, v142
  v_permlane16_swap_b32 v141, v143
  s_nop 0
  v_permlane32_swap_b32 v128, v130
  v_permlane32_swap_b32 v129, v131
  v_permlane32_swap_b32 v132, v134
  v_permlane32_swap_b32 v133, v135
  v_permlane32_swap_b32 v136, v138
  v_permlane32_swap_b32 v137, v139
  v_permlane32_swap_b32 v140, v142
  v_permlane32_swap_b32 v141, v143
  v_sub_f32 v146, 1.0, v144
  v_sub_f32 v147, 1.0, v145
  v_lshlrev_b32 v160, 16, v128
  v_and_b32 v161, 0xffff0000, v128
  v_lshlrev_b32 v162, 16, v129
  v_and_b32 v163, 0xffff0000, v129
  v_mul_f32 v160, v160, v146
  v_mul_f32 v161, v161, v146
  v_mul_f32 v162, v162, v146
  v_mul_f32 v163, v163, v146
  v_lshlrev_b32 v164, 16, v130
  v_and_b32 v165, 0xffff0000, v130
  v_lshlrev_b32 v166, 16, v131
  v_and_b32 v167, 0xffff0000, v131
  v_mul_f32 v164, v164, v146
  v_mul_f32 v165, v165, v146
  v_mul_f32 v166, v166, v146
  v_mul_f32 v167, v167, v146
  v_lshlrev_b32 v168, 16, v132
  v_and_b32 v169, 0xffff0000, v132
  v_lshlrev_b32 v170, 16, v133
  v_and_b32 v171, 0xffff0000, v133
  v_mul_f32 v168, v168, v146
  v_mul_f32 v169, v169, v146
  v_mul_f32 v170, v170, v146
  v_mul_f32 v171, v171, v146
  v_lshlrev_b32 v172, 16, v134
  v_and_b32 v173, 0xffff0000, v134
  v_lshlrev_b32 v174, 16, v135
  v_and_b32 v175, 0xffff0000, v135
  v_mul_f32 v172, v172, v146
  v_mul_f32 v173, v173, v146
  v_mul_f32 v174, v174, v146
  v_mul_f32 v175, v175, v146
  v_lshlrev_b32 v176, 16, v136
  v_and_b32 v177, 0xffff0000, v136
  v_lshlrev_b32 v178, 16, v137
  v_and_b32 v179, 0xffff0000, v137
  v_mul_f32 v176, v176, v147
  v_mul_f32 v177, v177, v147
  v_mul_f32 v178, v178, v147
  v_mul_f32 v179, v179, v147
  v_lshlrev_b32 v180, 16, v138
  v_and_b32 v181, 0xffff0000, v138
  v_lshlrev_b32 v182, 16, v139
  v_and_b32 v183, 0xffff0000, v139
  v_mul_f32 v180, v180, v147
  v_mul_f32 v181, v181, v147
  v_mul_f32 v182, v182, v147
  v_mul_f32 v183, v183, v147
  v_lshlrev_b32 v184, 16, v140
  v_and_b32 v185, 0xffff0000, v140
  v_lshlrev_b32 v186, 16, v141
  v_and_b32 v187, 0xffff0000, v141
  v_mul_f32 v184, v184, v147
  v_mul_f32 v185, v185, v147
  v_mul_f32 v186, v186, v147
  v_mul_f32 v187, v187, v147
  v_lshlrev_b32 v188, 16, v142
  v_and_b32 v189, 0xffff0000, v142
  v_lshlrev_b32 v190, 16, v143
  v_and_b32 v191, 0xffff0000, v143
  v_mul_f32 v188, v188, v147
  v_mul_f32 v189, v189, v147
  v_mul_f32 v190, v190, v147
  v_mul_f32 v191, v191, v147
  buffer_load_dword v235, v232, s[44:47], s78 offen sc1
  s_waitcnt vmcnt(7)
  s_waitcnt lgkmcnt(4)
  v_mfma_f32_16x16x32_bf16 v[0:3], v[96:99], v[32:35], 0
  ds_read_b64_tr_b16 v[112:113], v152 offset:4096
  v_mfma_f32_16x16x32_bf16 v[4:7], v[96:99], v[36:39], 0
  ds_read_b64_tr_b16 v[114:115], v152 offset:6144
  v_mfma_f32_16x16x32_bf16 v[8:11], v[100:103], v[32:35], 0
  ds_read_b64_tr_b16 v[116:117], v153 offset:4096
  v_mfma_f32_16x16x32_bf16 v[12:15], v[100:103], v[36:39], 0
  ds_read_b64_tr_b16 v[118:119], v153 offset:6144
  s_waitcnt lgkmcnt(4)
  v_mfma_f32_16x16x32_bf16 v[16:19], v[104:107], v[32:35], 0
  ds_read_b64_tr_b16 v[120:121], v154 offset:4096
  v_mfma_f32_16x16x32_bf16 v[20:23], v[104:107], v[36:39], 0
  ds_read_b64_tr_b16 v[122:123], v154 offset:6144
  v_mfma_f32_16x16x32_bf16 v[24:27], v[108:111], v[32:35], 0
  ds_read_b64_tr_b16 v[124:125], v155 offset:4096
  v_mfma_f32_16x16x32_bf16 v[28:31], v[108:111], v[36:39], 0
  ds_read_b64_tr_b16 v[126:127], v155 offset:6144
  s_add_u32 s60, s73, s6
  buffer_load_dwordx4 v[32:35], v194, s[44:47], s60 offen offset:0 sc1
  buffer_load_dwordx4 v[36:39], v195, s[44:47], s60 offen offset:0 sc1
  s_waitcnt vmcnt(7)
  s_waitcnt lgkmcnt(4)
  v_mfma_f32_16x16x32_bf16 v[0:3], v[112:115], v[40:43], v[0:3]
  ds_read_b64_tr_b16 v[96:97], v152 offset:8192
  v_mfma_f32_16x16x32_bf16 v[4:7], v[112:115], v[44:47], v[4:7]
  ds_read_b64_tr_b16 v[98:99], v152 offset:10240
  v_mfma_f32_16x16x32_bf16 v[8:11], v[116:119], v[40:43], v[8:11]
  ds_read_b64_tr_b16 v[100:101], v153 offset:8192
  v_mfma_f32_16x16x32_bf16 v[12:15], v[116:119], v[44:47], v[12:15]
  ds_read_b64_tr_b16 v[102:103], v153 offset:10240
  s_waitcnt lgkmcnt(4)
  v_mfma_f32_16x16x32_bf16 v[16:19], v[120:123], v[40:43], v[16:19]
  ds_read_b64_tr_b16 v[104:105], v154 offset:8192
  v_mfma_f32_16x16x32_bf16 v[20:23], v[120:123], v[44:47], v[20:23]
  ds_read_b64_tr_b16 v[106:107], v154 offset:10240
  v_mfma_f32_16x16x32_bf16 v[24:27], v[124:127], v[40:43], v[24:27]
  ds_read_b64_tr_b16 v[108:109], v155 offset:8192
  v_mfma_f32_16x16x32_bf16 v[28:31], v[124:127], v[44:47], v[28:31]
  ds_read_b64_tr_b16 v[110:111], v155 offset:10240
  buffer_load_dwordx4 v[40:43], v194, s[44:47], s60 offen offset:1024 sc1
  buffer_load_dwordx4 v[44:47], v195, s[44:47], s60 offen offset:1024 sc1
  s_waitcnt vmcnt(7)
  s_waitcnt lgkmcnt(4)
  v_mfma_f32_16x16x32_bf16 v[0:3], v[96:99], v[48:51], v[0:3]
  ds_read_b64_tr_b16 v[112:113], v152 offset:12288
  v_mfma_f32_16x16x32_bf16 v[4:7], v[96:99], v[52:55], v[4:7]
  ds_read_b64_tr_b16 v[114:115], v152 offset:14336
  v_mfma_f32_16x16x32_bf16 v[8:11], v[100:103], v[48:51], v[8:11]
  ds_read_b64_tr_b16 v[116:117], v153 offset:12288
  v_mfma_f32_16x16x32_bf16 v[12:15], v[100:103], v[52:55], v[12:15]
  ds_read_b64_tr_b16 v[118:119], v153 offset:14336
  s_waitcnt lgkmcnt(4)
  v_mfma_f32_16x16x32_bf16 v[16:19], v[104:107], v[48:51], v[16:19]
  ds_read_b64_tr_b16 v[120:121], v154 offset:12288
  v_mfma_f32_16x16x32_bf16 v[20:23], v[104:107], v[52:55], v[20:23]
  ds_read_b64_tr_b16 v[122:123], v154 offset:14336
  v_mfma_f32_16x16x32_bf16 v[24:27], v[108:111], v[48:51], v[24:27]
  ds_read_b64_tr_b16 v[124:125], v155 offset:12288
  v_mfma_f32_16x16x32_bf16 v[28:31], v[108:111], v[52:55], v[28:31]
  ds_read_b64_tr_b16 v[126:127], v155 offset:14336
  s_add_u32 s61, s73, s7
  buffer_load_dwordx4 v[48:51], v194, s[44:47], s61 offen offset:0 sc1
  buffer_load_dwordx4 v[52:55], v195, s[44:47], s61 offen offset:0 sc1
  s_waitcnt vmcnt(7)
  s_waitcnt lgkmcnt(4)
  v_mfma_f32_16x16x32_bf16 v[0:3], v[112:115], v[56:59], v[0:3]
  ds_read_b64_tr_b16 v[96:97], v152 offset:16384
  v_mfma_f32_16x16x32_bf16 v[4:7], v[112:115], v[60:63], v[4:7]
  ds_read_b64_tr_b16 v[98:99], v152 offset:18432
  v_mfma_f32_16x16x32_bf16 v[8:11], v[116:119], v[56:59], v[8:11]
  ds_read_b64_tr_b16 v[100:101], v153 offset:16384
  v_mfma_f32_16x16x32_bf16 v[12:15], v[116:119], v[60:63], v[12:15]
  ds_read_b64_tr_b16 v[102:103], v153 offset:18432
  s_waitcnt lgkmcnt(4)
  v_mfma_f32_16x16x32_bf16 v[16:19], v[120:123], v[56:59], v[16:19]
  ds_read_b64_tr_b16 v[104:105], v154 offset:16384
  v_mfma_f32_16x16x32_bf16 v[20:23], v[120:123], v[60:63], v[20:23]
  ds_read_b64_tr_b16 v[106:107], v154 offset:18432
  v_mfma_f32_16x16x32_bf16 v[24:27], v[124:127], v[56:59], v[24:27]
  ds_read_b64_tr_b16 v[108:109], v155 offset:16384
  v_mfma_f32_16x16x32_bf16 v[28:31], v[124:127], v[60:63], v[28:31]
  ds_read_b64_tr_b16 v[110:111], v155 offset:18432
  buffer_load_dwordx4 v[56:59], v194, s[44:47], s61 offen offset:1024 sc1
  buffer_load_dwordx4 v[60:63], v195, s[44:47], s61 offen offset:1024 sc1
  v_cmp_eq_u32 vcc, s68, v234
  s_nop 3
  s_and_b64 vcc, vcc, s[18:19]
  s_cmp_eq_u64 vcc, s[18:19]
  s_cbranch_scc1 L_pmd_27
  s_mov_b32 s82, 0
L_pm_26:
  buffer_load_dword v234, v232, s[44:47], s78 offen sc1
  s_waitcnt vmcnt(0)
  v_cmp_eq_u32 vcc, s68, v234
  s_add_u32 s82, s82, 1
  s_and_b64 vcc, vcc, s[18:19]
  s_cmp_eq_u64 vcc, s[18:19]
  s_cbranch_scc1 L_pmd_27
  s_cmp_lt_u32 s82, 200000
  s_cbranch_scc1 L_pm_26
L_pmd_27:
  s_waitcnt vmcnt(6)
  s_waitcnt lgkmcnt(4)
  v_mfma_f32_16x16x32_bf16 v[0:3], v[96:99], v[32:35], v[0:3]
  ds_read_b64_tr_b16 v[112:113], v152 offset:20480
  v_mfma_f32_16x16x32_bf16 v[4:7], v[96:99], v[36:39], v[4:7]
  ds_read_b64_tr_b16 v[114:115], v152 offset:22528
  v_mfma_f32_16x16x32_bf16 v[8:11], v[100:103], v[32:35], v[8:11]
  ds_read_b64_tr_b16 v[116:117], v153 offset:20480
  v_mfma_f32_16x16x32_bf16 v[12:15], v[100:103], v[36:39], v[12:15]
  ds_read_b64_tr_b16 v[118:119], v153 offset:22528
  s_waitcnt lgkmcnt(4)
  v_mfma_f32_16x16x32_bf16 v[16:19], v[104:107], v[32:35], v[16:19]
  ds_read_b64_tr_b16 v[120:121], v154 offset:20480
  v_mfma_f32_16x16x32_bf16 v[20:23], v[104:107], v[36:39], v[20:23]
  ds_read_b64_tr_b16 v[122:123], v154 offset:22528
  v_mfma_f32_16x16x32_bf16 v[24:27], v[108:111], v[32:35], v[24:27]
  ds_read_b64_tr_b16 v[124:125], v155 offset:20480
  v_mfma_f32_16x16x32_bf16 v[28:31], v[108:111], v[36:39], v[28:31]
  ds_read_b64_tr_b16 v[126:127], v155 offset:22528
  s_add_u32 s60, s73, s8
  buffer_load_dwordx4 v[32:35], v194, s[44:47], s60 offen offset:0 sc1
  buffer_load_dwordx4 v[36:39], v195, s[44:47], s60 offen offset:0 sc1
  s_waitcnt vmcnt(6)
  s_waitcnt lgkmcnt(4)
  v_mfma_f32_16x16x32_bf16 v[0:3], v[112:115], v[40:43], v[0:3]
  ds_read_b64_tr_b16 v[96:97], v152 offset:24576
  v_mfma_f32_16x16x32_bf16 v[4:7], v[112:115], v[44:47], v[4:7]
  ds_read_b64_tr_b16 v[98:99], v152 offset:26624
  v_mfma_f32_16x16x32_bf16 v[8:11], v[116:119], v[40:43], v[8:11]
  ds_read_b64_tr_b16 v[100:101], v153 offset:24576
  v_mfma_f32_16x16x32_bf16 v[12:15], v[116:119], v[44:47], v[12:15]
  ds_read_b64_tr_b16 v[102:103], v153 offset:26624
  s_waitcnt lgkmcnt(4)
  v_mfma_f32_16x16x32_bf16 v[16:19], v[120:123], v[40:43], v[16:19]
  ds_read_b64_tr_b16 v[104:105], v154 offset:24576
  v_mfma_f32_16x16x32_bf16 v[20:23], v[120:123], v[44:47], v[20:23]
  ds_read_b64_tr_b16 v[106:107], v154 offset:26624
  v_mfma_f32_16x16x32_bf16 v[24:27], v[124:127], v[40:43], v[24:27]
  ds_read_b64_tr_b16 v[108:109], v155 offset:24576
  v_mfma_f32_16x16x32_bf16 v[28:31], v[124:127], v[44:47], v[28:31]
  ds_read_b64_tr_b16 v[110:111], v155 offset:26624
  buffer_load_dwordx4 v[40:43], v194, s[44:47], s60 offen offset:1024 sc1
  buffer_load_dwordx4 v[44:47], v195, s[44:47], s60 offen offset:1024 sc1
  s_waitcnt vmcnt(6)
  s_waitcnt lgkmcnt(4)
  v_mfma_f32_16x16x32_bf16 v[0:3], v[96:99], v[48:51], v[0:3]
  ds_read_b64_tr_b16 v[112:113], v152 offset:28672
  v_mfma_f32_16x16x32_bf16 v[4:7], v[96:99], v[52:55], v[4:7]
  ds_read_b64_tr_b16 v[114:115], v152 offset:30720
  v_mfma_f32_16x16x32_bf16 v[8:11], v[100:103], v[48:51], v[8:11]
  ds_read_b64_tr_b16 v[116:117], v153 offset:28672
  v_mfma_f32_16x16x32_bf16 v[12:15], v[100:103], v[52:55], v[12:15]
  ds_read_b64_tr_b16 v[118:119], v153 offset:30720
  s_waitcnt lgkmcnt(4)
  v_mfma_f32_16x16x32_bf16 v[16:19], v[104:107], v[48:51], v[16:19]
  ds_read_b64_tr_b16 v[120:121], v154 offset:28672
  v_mfma_f32_16x16x32_bf16 v[20:23], v[104:107], v[52:55], v[20:23]
  ds_read_b64_tr_b16 v[122:123], v154 offset:30720
  v_mfma_f32_16x16x32_bf16 v[24:27], v[108:111], v[48:51], v[24:27]
  ds_read_b64_tr_b16 v[124:125], v155 offset:28672
  v_mfma_f32_16x16x32_bf16 v[28:31], v[108:111], v[52:55], v[28:31]
  ds_read_b64_tr_b16 v[126:127], v155 offset:30720
  s_add_u32 s61, s73, s9
  buffer_load_dwordx4 v[48:51], v194, s[44:47], s61 offen offset:0 sc1
  buffer_load_dwordx4 v[52:55], v195, s[44:47], s61 offen offset:0 sc1
  s_waitcnt vmcnt(6)
  s_waitcnt lgkmcnt(4)
  v_mfma_f32_16x16x32_bf16 v[0:3], v[112:115], v[56:59], v[0:3]
  ds_read_b64_tr_b16 v[96:97], v152 offset:32768
  v_mfma_f32_16x16x32_bf16 v[4:7], v[112:115], v[60:63], v[4:7]
  ds_read_b64_tr_b16 v[98:99], v152 offset:34816
  v_mfma_f32_16x16x32_bf16 v[8:11], v[116:119], v[56:59], v[8:11]
  ds_read_b64_tr_b16 v[100:101], v153 offset:32768
  v_mfma_f32_16x16x32_bf16 v[12:15], v[116:119], v[60:63], v[12:15]
  ds_read_b64_tr_b16 v[102:103], v153 offset:34816
  s_waitcnt lgkmcnt(4)
  v_mfma_f32_16x16x32_bf16 v[16:19], v[120:123], v[56:59], v[16:19]
  ds_read_b64_tr_b16 v[104:105], v154 offset:32768
  v_mfma_f32_16x16x32_bf16 v[20:23], v[120:123], v[60:63], v[20:23]
  ds_read_b64_tr_b16 v[106:107], v154 offset:34816
  v_mfma_f32_16x16x32_bf16 v[24:27], v[124:127], v[56:59], v[24:27]
  ds_read_b64_tr_b16 v[108:109], v155 offset:32768
  v_mfma_f32_16x16x32_bf16 v[28:31], v[124:127], v[60:63], v[28:31]
  ds_read_b64_tr_b16 v[110:111], v155 offset:34816
  buffer_load_dwordx4 v[56:59], v194, s[44:47], s61 offen offset:1024 sc1
  buffer_load_dwordx4 v[60:63], v195, s[44:47], s61 offen offset:1024 sc1
  buffer_load_dword v236, v232, s[44:47], s78 offen sc1
  s_waitcnt vmcnt(7)
  s_waitcnt lgkmcnt(4)
  v_mfma_f32_16x16x32_bf16 v[0:3], v[96:99], v[32:35], v[0:3]
  ds_read_b64_tr_b16 v[112:113], v152 offset:36864
  v_mfma_f32_16x16x32_bf16 v[4:7], v[96:99], v[36:39], v[4:7]
  ds_read_b64_tr_b16 v[114:115], v152 offset:38912
  v_mfma_f32_16x16x32_bf16 v[8:11], v[100:103], v[32:35], v[8:11]
  ds_read_b64_tr_b16 v[116:117], v153 offset:36864
  v_mfma_f32_16x16x32_bf16 v[12:15], v[100:103], v[36:39], v[12:15]
  ds_read_b64_tr_b16 v[118:119], v153 offset:38912
  s_waitcnt lgkmcnt(4)
  v_mfma_f32_16x16x32_bf16 v[16:19], v[104:107], v[32:35], v[16:19]
  ds_read_b64_tr_b16 v[120:121], v154 offset:36864
  v_mfma_f32_16x16x32_bf16 v[20:23], v[104:107], v[36:39], v[20:23]
  ds_read_b64_tr_b16 v[122:123], v154 offset:38912
  v_mfma_f32_16x16x32_bf16 v[24:27], v[108:111], v[32:35], v[24:27]
  ds_read_b64_tr_b16 v[124:125], v155 offset:36864
  v_mfma_f32_16x16x32_bf16 v[28:31], v[108:111], v[36:39], v[28:31]
  ds_read_b64_tr_b16 v[126:127], v155 offset:38912
  s_add_u32 s60, s73, s10
  buffer_load_dwordx4 v[32:35], v194, s[44:47], s60 offen offset:0 sc1
  buffer_load_dwordx4 v[36:39], v195, s[44:47], s60 offen offset:0 sc1
  s_waitcnt vmcnt(7)
  s_waitcnt lgkmcnt(4)
  v_mfma_f32_16x16x32_bf16 v[0:3], v[112:115], v[40:43], v[0:3]
  ds_read_b64_tr_b16 v[96:97], v152 offset:40960
  v_mfma_f32_16x16x32_bf16 v[4:7], v[112:115], v[44:47], v[4:7]
  ds_read_b64_tr_b16 v[98:99], v152 offset:43008
  v_mfma_f32_16x16x32_bf16 v[8:11], v[116:119], v[40:43], v[8:11]
  ds_read_b64_tr_b16 v[100:101], v153 offset:40960
  v_mfma_f32_16x16x32_bf16 v[12:15], v[116:119], v[44:47], v[12:15]
  ds_read_b64_tr_b16 v[102:103], v153 offset:43008
  s_waitcnt lgkmcnt(4)
  v_mfma_f32_16x16x32_bf16 v[16:19], v[120:123], v[40:43], v[16:19]
  ds_read_b64_tr_b16 v[104:105], v154 offset:40960
  v_mfma_f32_16x16x32_bf16 v[20:23], v[120:123], v[44:47], v[20:23]
  ds_read_b64_tr_b16 v[106:107], v154 offset:43008
  v_mfma_f32_16x16x32_bf16 v[24:27], v[124:127], v[40:43], v[24:27]
  ds_read_b64_tr_b16 v[108:109], v155 offset:40960
  v_mfma_f32_16x16x32_bf16 v[28:31], v[124:127], v[44:47], v[28:31]
  ds_read_b64_tr_b16 v[110:111], v155 offset:43008
  buffer_load_dwordx4 v[40:43], v194, s[44:47], s60 offen offset:1024 sc1
  buffer_load_dwordx4 v[44:47], v195, s[44:47], s60 offen offset:1024 sc1
  s_waitcnt vmcnt(7)
  s_waitcnt lgkmcnt(4)
  v_mfma_f32_16x16x32_bf16 v[0:3], v[96:99], v[48:51], v[0:3]
  ds_read_b64_tr_b16 v[112:113], v152 offset:45056
  v_mfma_f32_16x16x32_bf16 v[4:7], v[96:99], v[52:55], v[4:7]
  ds_read_b64_tr_b16 v[114:115], v152 offset:47104
  v_mfma_f32_16x16x32_bf16 v[8:11], v[100:103], v[48:51], v[8:11]
  ds_read_b64_tr_b16 v[116:117], v153 offset:45056
  v_mfma_f32_16x16x32_bf16 v[12:15], v[100:103], v[52:55], v[12:15]
  ds_read_b64_tr_b16 v[118:119], v153 offset:47104
  s_waitcnt lgkmcnt(4)
  v_mfma_f32_16x16x32_bf16 v[16:19], v[104:107], v[48:51], v[16:19]
  ds_read_b64_tr_b16 v[120:121], v154 offset:45056
  v_mfma_f32_16x16x32_bf16 v[20:23], v[104:107], v[52:55], v[20:23]
  ds_read_b64_tr_b16 v[122:123], v154 offset:47104
  v_mfma_f32_16x16x32_bf16 v[24:27], v[108:111], v[48:51], v[24:27]
  ds_read_b64_tr_b16 v[124:125], v155 offset:45056
  v_mfma_f32_16x16x32_bf16 v[28:31], v[108:111], v[52:55], v[28:31]
  ds_read_b64_tr_b16 v[126:127], v155 offset:47104
  s_add_u32 s61, s73, s11
  buffer_load_dwordx4 v[48:51], v194, s[44:47], s61 offen offset:0 sc1
  buffer_load_dwordx4 v[52:55], v195, s[44:47], s61 offen offset:0 sc1
  s_waitcnt vmcnt(7)
  s_waitcnt lgkmcnt(4)
  v_mfma_f32_16x16x32_bf16 v[0:3], v[112:115], v[56:59], v[0:3]
  ds_read_b64_tr_b16 v[96:97], v152 offset:49152
  v_mfma_f32_16x16x32_bf16 v[4:7], v[112:115], v[60:63], v[4:7]
  ds_read_b64_tr_b16 v[98:99], v152 offset:51200
  v_mfma_f32_16x16x32_bf16 v[8:11], v[116:119], v[56:59], v[8:11]
  ds_read_b64_tr_b16 v[100:101], v153 offset:49152
  v_mfma_f32_16x16x32_bf16 v[12:15], v[116:119], v[60:63], v[12:15]
  ds_read_b64_tr_b16 v[102:103], v153 offset:51200
  s_waitcnt lgkmcnt(4)
  v_mfma_f32_16x16x32_bf16 v[16:19], v[120:123], v[56:59], v[16:19]
  ds_read_b64_tr_b16 v[104:105], v154 offset:49152
  v_mfma_f32_16x16x32_bf16 v[20:23], v[120:123], v[60:63], v[20:23]
  ds_read_b64_tr_b16 v[106:107], v154 offset:51200
  v_mfma_f32_16x16x32_bf16 v[24:27], v[124:127], v[56:59], v[24:27]
  ds_read_b64_tr_b16 v[108:109], v155 offset:49152
  v_mfma_f32_16x16x32_bf16 v[28:31], v[124:127], v[60:63], v[28:31]
  ds_read_b64_tr_b16 v[110:111], v155 offset:51200
  buffer_load_dwordx4 v[56:59], v194, s[44:47], s61 offen offset:1024 sc1
  buffer_load_dwordx4 v[60:63], v195, s[44:47], s61 offen offset:1024 sc1
  v_cmp_eq_u32 vcc, s68, v235
  s_nop 3
  s_and_b64 vcc, vcc, s[20:21]
  s_cmp_eq_u64 vcc, s[20:21]
  s_cbranch_scc1 L_pmd_29
  s_mov_b32 s82, 0
L_pm_28:
  buffer_load_dword v234, v232, s[44:47], s78 offen sc1
  s_waitcnt vmcnt(0)
  v_cmp_eq_u32 vcc, s68, v234
  s_add_u32 s82, s82, 1
  s_and_b64 vcc, vcc, s[20:21]
  s_cmp_eq_u64 vcc, s[20:21]
  s_cbranch_scc1 L_pmd_29
  s_cmp_lt_u32 s82, 200000
  s_cbranch_scc1 L_pm_28
L_pmd_29:
  s_waitcnt vmcnt(6)
  s_waitcnt lgkmcnt(4)
  v_mfma_f32_16x16x32_bf16 v[0:3], v[96:99], v[32:35], v[0:3]
  ds_read_b64_tr_b16 v[112:113], v152 offset:53248
  v_mfma_f32_16x16x32_bf16 v[4:7], v[96:99], v[36:39], v[4:7]
  ds_read_b64_tr_b16 v[114:115], v152 offset:55296
  v_mfma_f32_16x16x32_bf16 v[8:11], v[100:103], v[32:35], v[8:11]
  ds_read_b64_tr_b16 v[116:117], v153 offset:53248
  v_mfma_f32_16x16x32_bf16 v[12:15], v[100:103], v[36:39], v[12:15]
  ds_read_b64_tr_b16 v[118:119], v153 offset:55296
  s_waitcnt lgkmcnt(4)
  v_mfma_f32_16x16x32_bf16 v[16:19], v[104:107], v[32:35], v[16:19]
  ds_read_b64_tr_b16 v[120:121], v154 offset:53248
  v_mfma_f32_16x16x32_bf16 v[20:23], v[104:107], v[36:39], v[20:23]
  ds_read_b64_tr_b16 v[122:123], v154 offset:55296
  v_mfma_f32_16x16x32_bf16 v[24:27], v[108:111], v[32:35], v[24:27]
  ds_read_b64_tr_b16 v[124:125], v155 offset:53248
  v_mfma_f32_16x16x32_bf16 v[28:31], v[108:111], v[36:39], v[28:31]
  ds_read_b64_tr_b16 v[126:127], v155 offset:55296
  s_add_u32 s60, s73, s12
  buffer_load_dwordx4 v[32:35], v194, s[44:47], s60 offen offset:0 sc1
  buffer_load_dwordx4 v[36:39], v195, s[44:47], s60 offen offset:0 sc1
  s_waitcnt vmcnt(6)
  s_waitcnt lgkmcnt(4)
  v_mfma_f32_16x16x32_bf16 v[0:3], v[112:115], v[40:43], v[0:3]
  ds_read_b64_tr_b16 v[96:97], v152 offset:57344
  v_mfma_f32_16x16x32_bf16 v[4:7], v[112:115], v[44:47], v[4:7]
  ds_read_b64_tr_b16 v[98:99], v152 offset:59392
  v_mfma_f32_16x16x32_bf16 v[8:11], v[116:119], v[40:43], v[8:11]
  ds_read_b64_tr_b16 v[100:101], v153 offset:57344
  v_mfma_f32_16x16x32_bf16 v[12:15], v[116:119], v[44:47], v[12:15]
  ds_read_b64_tr_b16 v[102:103], v153 offset:59392
  s_waitcnt lgkmcnt(4)
  v_mfma_f32_16x16x32_bf16 v[16:19], v[120:123], v[40:43], v[16:19]
  ds_read_b64_tr_b16 v[104:105], v154 offset:57344
  v_mfma_f32_16x16x32_bf16 v[20:23], v[120:123], v[44:47], v[20:23]
  ds_read_b64_tr_b16 v[106:107], v154 offset:59392
  v_mfma_f32_16x16x32_bf16 v[24:27], v[124:127], v[40:43], v[24:27]
  ds_read_b64_tr_b16 v[108:109], v155 offset:57344
  v_mfma_f32_16x16x32_bf16 v[28:31], v[124:127], v[44:47], v[28:31]
  ds_read_b64_tr_b16 v[110:111], v155 offset:59392
  buffer_load_dwordx4 v[40:43], v194, s[44:47], s60 offen offset:1024 sc1
  buffer_load_dwordx4 v[44:47], v195, s[44:47], s60 offen offset:1024 sc1
  s_waitcnt vmcnt(6)
  s_waitcnt lgkmcnt(4)
  v_mfma_f32_16x16x32_bf16 v[0:3], v[96:99], v[48:51], v[0:3]
  ds_read_b64_tr_b16 v[112:113], v152 offset:61440
  v_mfma_f32_16x16x32_bf16 v[4:7], v[96:99], v[52:55], v[4:7]
  ds_read_b64_tr_b16 v[114:115], v152 offset:63488
  v_mfma_f32_16x16x32_bf16 v[8:11], v[100:103], v[48:51], v[8:11]
  ds_read_b64_tr_b16 v[116:117], v153 offset:61440
  v_mfma_f32_16x16x32_bf16 v[12:15], v[100:103], v[52:55], v[12:15]
  ds_read_b64_tr_b16 v[118:119], v153 offset:63488
  s_waitcnt lgkmcnt(4)
  v_mfma_f32_16x16x32_bf16 v[16:19], v[104:107], v[48:51], v[16:19]
  ds_read_b64_tr_b16 v[120:121], v154 offset:61440
  v_mfma_f32_16x16x32_bf16 v[20:23], v[104:107], v[52:55], v[20:23]
  ds_read_b64_tr_b16 v[122:123], v154 offset:63488
  v_mfma_f32_16x16x32_bf16 v[24:27], v[108:111], v[48:51], v[24:27]
  ds_read_b64_tr_b16 v[124:125], v155 offset:61440
  v_mfma_f32_16x16x32_bf16 v[28:31], v[108:111], v[52:55], v[28:31]
  ds_read_b64_tr_b16 v[126:127], v155 offset:63488
  s_add_u32 s61, s73, s13
  buffer_load_dwordx4 v[48:51], v194, s[44:47], s61 offen offset:0 sc1
  buffer_load_dwordx4 v[52:55], v195, s[44:47], s61 offen offset:0 sc1
  s_waitcnt vmcnt(6)
  s_mov_b32 s81, 0
L_lp_30:
  ds_read_b32 v237, v230 offset:48
  s_waitcnt lgkmcnt(0)
  v_readfirstlane_b32 s80, v237
  s_add_u32 s81, s81, 1
  s_cmp_ge_u32 s80, 4
  s_cbranch_scc1 L_lpd_31
  s_cmp_lt_u32 s81, 3200000
  s_cbranch_scc1 L_lp_30
L_lpd_31:
  s_waitcnt lgkmcnt(4)
  v_mfma_f32_16x16x32_bf16 v[0:3], v[112:115], v[56:59], v[0:3]
  ds_read_b64_tr_b16 v[96:97], v148 offset:0
  v_mfma_f32_16x16x32_bf16 v[4:7], v[112:115], v[60:63], v[4:7]
  ds_read_b64_tr_b16 v[98:99], v148 offset:2048
  v_mfma_f32_16x16x32_bf16 v[8:11], v[116:119], v[56:59], v[8:11]
  ds_read_b64_tr_b16 v[100:101], v149 offset:0
  v_mfma_f32_16x16x32_bf16 v[12:15], v[116:119], v[60:63], v[12:15]
  ds_read_b64_tr_b16 v[102:103], v149 offset:2048
  s_waitcnt lgkmcnt(4)
  v_mfma_f32_16x16x32_bf16 v[16:19], v[120:123], v[56:59], v[16:19]
  ds_read_b64_tr_b16 v[104:105], v150 offset:0
  v_mfma_f32_16x16x32_bf16 v[20:23], v[120:123], v[60:63], v[20:23]
  ds_read_b64_tr_b16 v[106:107], v150 offset:2048
  v_mfma_f32_16x16x32_bf16 v[24:27], v[124:127], v[56:59], v[24:27]
  ds_read_b64_tr_b16 v[108:109], v151 offset:0
  v_mfma_f32_16x16x32_bf16 v[28:31], v[124:127], v[60:63], v[28:31]
  ds_read_b64_tr_b16 v[110:111], v151 offset:2048
  buffer_load_dwordx4 v[56:59], v194, s[44:47], s61 offen offset:1024 sc1
  buffer_load_dwordx4 v[60:63], v195, s[44:47], s61 offen offset:1024 sc1
  s_waitcnt vmcnt(6)
  s_waitcnt lgkmcnt(4)
  v_mfma_f32_16x16x32_bf16 v[0:3], v[96:99], v[32:35], v[0:3]
  ds_read_b64_tr_b16 v[112:113], v148 offset:4096
  v_mfma_f32_16x16x32_bf16 v[4:7], v[96:99], v[36:39], v[4:7]
  ds_read_b64_tr_b16 v[114:115], v148 offset:6144
  v_mfma_f32_16x16x32_bf16 v[8:11], v[100:103], v[32:35], v[8:11]
  ds_read_b64_tr_b16 v[116:117], v149 offset:4096
  v_mfma_f32_16x16x32_bf16 v[12:15], v[100:103], v[36:39], v[12:15]
  ds_read_b64_tr_b16 v[118:119], v149 offset:6144
  s_waitcnt lgkmcnt(4)
  v_mfma_f32_16x16x32_bf16 v[16:19], v[104:107], v[32:35], v[16:19]
  ds_read_b64_tr_b16 v[120:121], v150 offset:4096
  v_mfma_f32_16x16x32_bf16 v[20:23], v[104:107], v[36:39], v[20:23]
  ds_read_b64_tr_b16 v[122:123], v150 offset:6144
  v_mfma_f32_16x16x32_bf16 v[24:27], v[108:111], v[32:35], v[24:27]
  ds_read_b64_tr_b16 v[124:125], v151 offset:4096
  v_mfma_f32_16x16x32_bf16 v[28:31], v[108:111], v[36:39], v[28:31]
  ds_read_b64_tr_b16 v[126:127], v151 offset:6144
  s_add_u32 s60, s73, s14
  buffer_load_dwordx4 v[32:35], v194, s[44:47], s60 offen offset:0 sc1
  buffer_load_dwordx4 v[36:39], v195, s[44:47], s60 offen offset:0 sc1
  s_waitcnt vmcnt(6)
  s_waitcnt lgkmcnt(4)
  v_mfma_f32_16x16x32_bf16 v[0:3], v[112:115], v[40:43], v[0:3]
  ds_read_b64_tr_b16 v[96:97], v148 offset:8192
  v_mfma_f32_16x16x32_bf16 v[4:7], v[112:115], v[44:47], v[4:7]
  ds_read_b64_tr_b16 v[98:99], v148 offset:10240
  v_mfma_f32_16x16x32_bf16 v[8:11], v[116:119], v[40:43], v[8:11]
  ds_read_b64_tr_b16 v[100:101], v149 offset:8192
  v_mfma_f32_16x16x32_bf16 v[12:15], v[116:119], v[44:47], v[12:15]
  ds_read_b64_tr_b16 v[102:103], v149 offset:10240
  s_waitcnt lgkmcnt(4)
  v_mfma_f32_16x16x32_bf16 v[16:19], v[120:123], v[40:43], v[16:19]
  ds_read_b64_tr_b16 v[104:105], v150 offset:8192
  v_mfma_f32_16x16x32_bf16 v[20:23], v[120:123], v[44:47], v[20:23]
  ds_read_b64_tr_b16 v[106:107], v150 offset:10240
  v_mfma_f32_16x16x32_bf16 v[24:27], v[124:127], v[40:43], v[24:27]
  ds_read_b64_tr_b16 v[108:109], v151 offset:8192
  v_mfma_f32_16x16x32_bf16 v[28:31], v[124:127], v[44:47], v[28:31]
  ds_read_b64_tr_b16 v[110:111], v151 offset:10240
  buffer_load_dwordx4 v[40:43], v194, s[44:47], s60 offen offset:1024 sc1
  buffer_load_dwordx4 v[44:47], v195, s[44:47], s60 offen offset:1024 sc1
  s_waitcnt vmcnt(6)
  s_waitcnt lgkmcnt(4)
  v_mfma_f32_16x16x32_bf16 v[0:3], v[96:99], v[48:51], v[0:3]
  ds_read_b64_tr_b16 v[112:113], v148 offset:12288
  v_mfma_f32_16x16x32_bf16 v[4:7], v[96:99], v[52:55], v[4:7]
  ds_read_b64_tr_b16 v[114:115], v148 offset:14336
  v_mfma_f32_16x16x32_bf16 v[8:11], v[100:103], v[48:51], v[8:11]
  ds_read_b64_tr_b16 v[116:117], v149 offset:12288
  v_mfma_f32_16x16x32_bf16 v[12:15], v[100:103], v[52:55], v[12:15]
  ds_read_b64_tr_b16 v[118:119], v149 offset:14336
  s_waitcnt lgkmcnt(4)
  v_mfma_f32_16x16x32_bf16 v[16:19], v[104:107], v[48:51], v[16:19]
  ds_read_b64_tr_b16 v[120:121], v150 offset:12288
  v_mfma_f32_16x16x32_bf16 v[20:23], v[104:107], v[52:55], v[20:23]
  ds_read_b64_tr_b16 v[122:123], v150 offset:14336
  v_mfma_f32_16x16x32_bf16 v[24:27], v[108:111], v[48:51], v[24:27]
  ds_read_b64_tr_b16 v[124:125], v151 offset:12288
  v_mfma_f32_16x16x32_bf16 v[28:31], v[108:111], v[52:55], v[28:31]
  ds_read_b64_tr_b16 v[126:127], v151 offset:14336
  s_add_u32 s61, s73, s15
  buffer_load_dwordx4 v[48:51], v194, s[44:47], s61 offen offset:0 sc1
  buffer_load_dwordx4 v[52:55], v195, s[44:47], s61 offen offset:0 sc1
  s_waitcnt vmcnt(6)
  s_waitcnt lgkmcnt(4)
  v_mfma_f32_16x16x32_bf16 v[0:3], v[112:115], v[56:59], v[0:3]
  ds_read_b64_tr_b16 v[96:97], v148 offset:16384
  v_mfma_f32_16x16x32_bf16 v[4:7], v[112:115], v[60:63], v[4:7]
  ds_read_b64_tr_b16 v[98:99], v148 offset:18432
  v_mfma_f32_16x16x32_bf16 v[8:11], v[116:119], v[56:59], v[8:11]
  ds_read_b64_tr_b16 v[100:101], v149 offset:16384
  v_mfma_f32_16x16x32_bf16 v[12:15], v[116:119], v[60:63], v[12:15]
  ds_read_b64_tr_b16 v[102:103], v149 offset:18432
  s_waitcnt lgkmcnt(4)
  v_mfma_f32_16x16x32_bf16 v[16:19], v[120:123], v[56:59], v[16:19]
  ds_read_b64_tr_b16 v[104:105], v150 offset:16384
  v_mfma_f32_16x16x32_bf16 v[20:23], v[120:123], v[60:63], v[20:23]
  ds_read_b64_tr_b16 v[106:107], v150 offset:18432
  v_mfma_f32_16x16x32_bf16 v[24:27], v[124:127], v[56:59], v[24:27]
  ds_read_b64_tr_b16 v[108:109], v151 offset:16384
  v_mfma_f32_16x16x32_bf16 v[28:31], v[124:127], v[60:63], v[28:31]
  ds_read_b64_tr_b16 v[110:111], v151 offset:18432
  buffer_load_dwordx4 v[56:59], v194, s[44:47], s61 offen offset:1024 sc1
  buffer_load_dwordx4 v[60:63], v195, s[44:47], s61 offen offset:1024 sc1
  v_cmp_eq_u32 vcc, s68, v236
  s_nop 3
  s_and_b64 vcc, vcc, s[22:23]
  s_cmp_eq_u64 vcc, s[22:23]
  s_cbranch_scc1 L_pmd_33
  s_mov_b32 s82, 0
L_pm_32:
  buffer_load_dword v234, v232, s[44:47], s78 offen sc1
  s_waitcnt vmcnt(0)
  v_cmp_eq_u32 vcc, s68, v234
  s_add_u32 s82, s82, 1
  s_and_b64 vcc, vcc, s[22:23]
  s_cmp_eq_u64 vcc, s[22:23]
  s_cbranch_scc1 L_pmd_33
  s_cmp_lt_u32 s82, 200000
  s_cbranch_scc1 L_pm_32
L_pmd_33:
  s_waitcnt vmcnt(6)
  s_waitcnt lgkmcnt(4)
  v_mfma_f32_16x16x32_bf16 v[0:3], v[96:99], v[32:35], v[0:3]
  ds_read_b64_tr_b16 v[112:113], v148 offset:20480
  v_mfma_f32_16x16x32_bf16 v[4:7], v[96:99], v[36:39], v[4:7]
  ds_read_b64_tr_b16 v[114:115], v148 offset:22528
  v_mfma_f32_16x16x32_bf16 v[8:11], v[100:103], v[32:35], v[8:11]
  ds_read_b64_tr_b16 v[116:117], v149 offset:20480
  v_mfma_f32_16x16x32_bf16 v[12:15], v[100:103], v[36:39], v[12:15]
  ds_read_b64_tr_b16 v[118:119], v149 offset:22528
  s_waitcnt lgkmcnt(4)
  v_mfma_f32_16x16x32_bf16 v[16:19], v[104:107], v[32:35], v[16:19]
  ds_read_b64_tr_b16 v[120:121], v150 offset:20480
  v_mfma_f32_16x16x32_bf16 v[20:23], v[104:107], v[36:39], v[20:23]
  ds_read_b64_tr_b16 v[122:123], v150 offset:22528
  v_mfma_f32_16x16x32_bf16 v[24:27], v[108:111], v[32:35], v[24:27]
  ds_read_b64_tr_b16 v[124:125], v151 offset:20480
  v_mfma_f32_16x16x32_bf16 v[28:31], v[108:111], v[36:39], v[28:31]
  ds_read_b64_tr_b16 v[126:127], v151 offset:22528
  s_add_u32 s60, s73, s56
  buffer_load_dwordx4 v[32:35], v194, s[44:47], s60 offen offset:0 sc1
  buffer_load_dwordx4 v[36:39], v195, s[44:47], s60 offen offset:0 sc1
  s_waitcnt vmcnt(6)
  s_waitcnt lgkmcnt(4)
  v_mfma_f32_16x16x32_bf16 v[0:3], v[112:115], v[40:43], v[0:3]
  ds_read_b64_tr_b16 v[96:97], v148 offset:24576
  v_mfma_f32_16x16x32_bf16 v[4:7], v[112:115], v[44:47], v[4:7]
  ds_read_b64_tr_b16 v[98:99], v148 offset:26624
  v_mfma_f32_16x16x32_bf16 v[8:11], v[116:119], v[40:43], v[8:11]
  ds_read_b64_tr_b16 v[100:101], v149 offset:24576
  v_mfma_f32_16x16x32_bf16 v[12:15], v[116:119], v[44:47], v[12:15]
  ds_read_b64_tr_b16 v[102:103], v149 offset:26624
  s_waitcnt lgkmcnt(4)
  v_mfma_f32_16x16x32_bf16 v[16:19], v[120:123], v[40:43], v[16:19]
  ds_read_b64_tr_b16 v[104:105], v150 offset:24576
  v_mfma_f32_16x16x32_bf16 v[20:23], v[120:123], v[44:47], v[20:23]
  ds_read_b64_tr_b16 v[106:107], v150 offset:26624
  v_mfma_f32_16x16x32_bf16 v[24:27], v[124:127], v[40:43], v[24:27]
  ds_read_b64_tr_b16 v[108:109], v151 offset:24576
  v_mfma_f32_16x16x32_bf16 v[28:31], v[124:127], v[44:47], v[28:31]
  ds_read_b64_tr_b16 v[110:111], v151 offset:26624
  buffer_load_dwordx4 v[40:43], v194, s[44:47], s60 offen offset:1024 sc1
  buffer_load_dwordx4 v[44:47], v195, s[44:47], s60 offen offset:1024 sc1
  s_waitcnt vmcnt(6)
  s_waitcnt lgkmcnt(4)
  v_mfma_f32_16x16x32_bf16 v[0:3], v[96:99], v[48:51], v[0:3]
  ds_read_b64_tr_b16 v[112:113], v148 offset:28672
  v_mfma_f32_16x16x32_bf16 v[4:7], v[96:99], v[52:55], v[4:7]
  ds_read_b64_tr_b16 v[114:115], v148 offset:30720
  v_mfma_f32_16x16x32_bf16 v[8:11], v[100:103], v[48:51], v[8:11]
  ds_read_b64_tr_b16 v[116:117], v149 offset:28672
  v_mfma_f32_16x16x32_bf16 v[12:15], v[100:103], v[52:55], v[12:15]
  ds_read_b64_tr_b16 v[118:119], v149 offset:30720
  s_waitcnt lgkmcnt(4)
  v_mfma_f32_16x16x32_bf16 v[16:19], v[104:107], v[48:51], v[16:19]
  ds_read_b64_tr_b16 v[120:121], v150 offset:28672
  v_mfma_f32_16x16x32_bf16 v[20:23], v[104:107], v[52:55], v[20:23]
  ds_read_b64_tr_b16 v[122:123], v150 offset:30720
  v_mfma_f32_16x16x32_bf16 v[24:27], v[108:111], v[48:51], v[24:27]
  ds_read_b64_tr_b16 v[124:125], v151 offset:28672
  v_mfma_f32_16x16x32_bf16 v[28:31], v[108:111], v[52:55], v[28:31]
  ds_read_b64_tr_b16 v[126:127], v151 offset:30720
  s_add_u32 s61, s73, s57
  buffer_load_dwordx4 v[48:51], v194, s[44:47], s61 offen offset:0 sc1
  buffer_load_dwordx4 v[52:55], v195, s[44:47], s61 offen offset:0 sc1
  s_waitcnt vmcnt(6)
  s_waitcnt lgkmcnt(4)
  v_mfma_f32_16x16x32_bf16 v[0:3], v[112:115], v[56:59], v[0:3]
  ds_read_b64_tr_b16 v[96:97], v148 offset:32768
  v_mfma_f32_16x16x32_bf16 v[4:7], v[112:115], v[60:63], v[4:7]
  ds_read_b64_tr_b16 v[98:99], v148 offset:34816
  v_mfma_f32_16x16x32_bf16 v[8:11], v[116:119], v[56:59], v[8:11]
  ds_read_b64_tr_b16 v[100:101], v149 offset:32768
  v_mfma_f32_16x16x32_bf16 v[12:15], v[116:119], v[60:63], v[12:15]
  ds_read_b64_tr_b16 v[102:103], v149 offset:34816
  s_waitcnt lgkmcnt(4)
  v_mfma_f32_16x16x32_bf16 v[16:19], v[120:123], v[56:59], v[16:19]
  ds_read_b64_tr_b16 v[104:105], v150 offset:32768
  v_mfma_f32_16x16x32_bf16 v[20:23], v[120:123], v[60:63], v[20:23]
  ds_read_b64_tr_b16 v[106:107], v150 offset:34816
  v_mfma_f32_16x16x32_bf16 v[24:27], v[124:127], v[56:59], v[24:27]
  ds_read_b64_tr_b16 v[108:109], v151 offset:32768
  v_mfma_f32_16x16x32_bf16 v[28:31], v[124:127], v[60:63], v[28:31]
  ds_read_b64_tr_b16 v[110:111], v151 offset:34816
  buffer_load_dwordx4 v[56:59], v194, s[44:47], s61 offen offset:1024 sc1
  buffer_load_dwordx4 v[60:63], v195, s[44:47], s61 offen offset:1024 sc1
  s_waitcnt vmcnt(6)
  s_waitcnt lgkmcnt(4)
  v_mfma_f32_16x16x32_bf16 v[0:3], v[96:99], v[32:35], v[0:3]
  ds_read_b64_tr_b16 v[112:113], v148 offset:36864
  v_mfma_f32_16x16x32_bf16 v[4:7], v[96:99], v[36:39], v[4:7]
  ds_read_b64_tr_b16 v[114:115], v148 offset:38912
  v_mfma_f32_16x16x32_bf16 v[8:11], v[100:103], v[32:35], v[8:11]
  ds_read_b64_tr_b16 v[116:117], v149 offset:36864
  v_mfma_f32_16x16x32_bf16 v[12:15], v[100:103], v[36:39], v[12:15]
  ds_read_b64_tr_b16 v[118:119], v149 offset:38912
  s_waitcnt lgkmcnt(4)
  v_mfma_f32_16x16x32_bf16 v[16:19], v[104:107], v[32:35], v[16:19]
  ds_read_b64_tr_b16 v[120:121], v150 offset:36864
  v_mfma_f32_16x16x32_bf16 v[20:23], v[104:107], v[36:39], v[20:23]
  ds_read_b64_tr_b16 v[122:123], v150 offset:38912
  v_mfma_f32_16x16x32_bf16 v[24:27], v[108:111], v[32:35], v[24:27]
  ds_read_b64_tr_b16 v[124:125], v151 offset:36864
  v_mfma_f32_16x16x32_bf16 v[28:31], v[108:111], v[36:39], v[28:31]
  ds_read_b64_tr_b16 v[126:127], v151 offset:38912
  s_add_u32 s60, s73, s58
  buffer_load_dwordx4 v[32:35], v194, s[44:47], s60 offen offset:0 sc1
  buffer_load_dwordx4 v[36:39], v195, s[44:47], s60 offen offset:0 sc1
  s_waitcnt vmcnt(6)
  s_waitcnt lgkmcnt(4)
  v_mfma_f32_16x16x32_bf16 v[0:3], v[112:115], v[40:43], v[0:3]
  ds_read_b64_tr_b16 v[96:97], v148 offset:40960
  v_mfma_f32_16x16x32_bf16 v[4:7], v[112:115], v[44:47], v[4:7]
  ds_read_b64_tr_b16 v[98:99], v148 offset:43008
  v_mfma_f32_16x16x32_bf16 v[8:11], v[116:119], v[40:43], v[8:11]
  ds_read_b64_tr_b16 v[100:101], v149 offset:40960
  v_mfma_f32_16x16x32_bf16 v[12:15], v[116:119], v[44:47], v[12:15]
  ds_read_b64_tr_b16 v[102:103], v149 offset:43008
  s_waitcnt lgkmcnt(4)
  v_mfma_f32_16x16x32_bf16 v[16:19], v[120:123], v[40:43], v[16:19]
  ds_read_b64_tr_b16 v[104:105], v150 offset:40960
  v_mfma_f32_16x16x32_bf16 v[20:23], v[120:123], v[44:47], v[20:23]
  ds_read_b64_tr_b16 v[106:107], v150 offset:43008
  v_mfma_f32_16x16x32_bf16 v[24:27], v[124:127], v[40:43], v[24:27]
  ds_read_b64_tr_b16 v[108:109], v151 offset:40960
  v_mfma_f32_16x16x32_bf16 v[28:31], v[124:127], v[44:47], v[28:31]
  ds_read_b64_tr_b16 v[110:111], v151 offset:43008
  buffer_load_dwordx4 v[40:43], v194, s[44:47], s60 offen offset:1024 sc1
  buffer_load_dwordx4 v[44:47], v195, s[44:47], s60 offen offset:1024 sc1
  s_waitcnt vmcnt(6)
  s_waitcnt lgkmcnt(4)
  v_mfma_f32_16x16x32_bf16 v[0:3], v[96:99], v[48:51], v[0:3]
  ds_read_b64_tr_b16 v[112:113], v148 offset:45056
  v_mfma_f32_16x16x32_bf16 v[4:7], v[96:99], v[52:55], v[4:7]
  ds_read_b64_tr_b16 v[114:115], v148 offset:47104
  v_mfma_f32_16x16x32_bf16 v[8:11], v[100:103], v[48:51], v[8:11]
  ds_read_b64_tr_b16 v[116:117], v149 offset:45056
  v_mfma_f32_16x16x32_bf16 v[12:15], v[100:103], v[52:55], v[12:15]
  ds_read_b64_tr_b16 v[118:119], v149 offset:47104
  s_waitcnt lgkmcnt(4)
  v_mfma_f32_16x16x32_bf16 v[16:19], v[104:107], v[48:51], v[16:19]
  ds_read_b64_tr_b16 v[120:121], v150 offset:45056
  v_mfma_f32_16x16x32_bf16 v[20:23], v[104:107], v[52:55], v[20:23]
  ds_read_b64_tr_b16 v[122:123], v150 offset:47104
  v_mfma_f32_16x16x32_bf16 v[24:27], v[108:111], v[48:51], v[24:27]
  ds_read_b64_tr_b16 v[124:125], v151 offset:45056
  v_mfma_f32_16x16x32_bf16 v[28:31], v[108:111], v[52:55], v[28:31]
  ds_read_b64_tr_b16 v[126:127], v151 offset:47104
  s_add_u32 s61, s73, s59
  buffer_load_dwordx4 v[48:51], v194, s[44:47], s61 offen offset:0 sc1
  buffer_load_dwordx4 v[52:55], v195, s[44:47], s61 offen offset:0 sc1
  s_waitcnt vmcnt(6)
  s_waitcnt lgkmcnt(4)
  v_mfma_f32_16x16x32_bf16 v[0:3], v[112:115], v[56:59], v[0:3]
  ds_read_b64_tr_b16 v[96:97], v148 offset:49152
  v_mfma_f32_16x16x32_bf16 v[4:7], v[112:115], v[60:63], v[4:7]
  ds_read_b64_tr_b16 v[98:99], v148 offset:51200
  v_mfma_f32_16x16x32_bf16 v[8:11], v[116:119], v[56:59], v[8:11]
  ds_read_b64_tr_b16 v[100:101], v149 offset:49152
  v_mfma_f32_16x16x32_bf16 v[12:15], v[116:119], v[60:63], v[12:15]
  ds_read_b64_tr_b16 v[102:103], v149 offset:51200
  s_waitcnt lgkmcnt(4)
  v_mfma_f32_16x16x32_bf16 v[16:19], v[120:123], v[56:59], v[16:19]
  ds_read_b64_tr_b16 v[104:105], v150 offset:49152
  v_mfma_f32_16x16x32_bf16 v[20:23], v[120:123], v[60:63], v[20:23]
  ds_read_b64_tr_b16 v[106:107], v150 offset:51200
  v_mfma_f32_16x16x32_bf16 v[24:27], v[124:127], v[56:59], v[24:27]
  ds_read_b64_tr_b16 v[108:109], v151 offset:49152
  v_mfma_f32_16x16x32_bf16 v[28:31], v[124:127], v[60:63], v[28:31]
  ds_read_b64_tr_b16 v[110:111], v151 offset:51200
  buffer_load_dwordx4 v[56:59], v194, s[44:47], s61 offen offset:1024 sc1
  buffer_load_dwordx4 v[60:63], v195, s[44:47], s61 offen offset:1024 sc1
  s_waitcnt vmcnt(6)
  s_waitcnt lgkmcnt(4)
  v_mfma_f32_16x16x32_bf16 v[0:3], v[96:99], v[32:35], v[0:3]
  ds_read_b64_tr_b16 v[112:113], v148 offset:53248
  v_mfma_f32_16x16x32_bf16 v[4:7], v[96:99], v[36:39], v[4:7]
  ds_read_b64_tr_b16 v[114:115], v148 offset:55296
  v_mfma_f32_16x16x32_bf16 v[8:11], v[100:103], v[32:35], v[8:11]
  ds_read_b64_tr_b16 v[116:117], v149 offset:53248
  v_mfma_f32_16x16x32_bf16 v[12:15], v[100:103], v[36:39], v[12:15]
  ds_read_b64_tr_b16 v[118:119], v149 offset:55296
  s_waitcnt lgkmcnt(4)
  v_mfma_f32_16x16x32_bf16 v[16:19], v[104:107], v[32:35], v[16:19]
  ds_read_b64_tr_b16 v[120:121], v150 offset:53248
  v_mfma_f32_16x16x32_bf16 v[20:23], v[104:107], v[36:39], v[20:23]
  ds_read_b64_tr_b16 v[122:123], v150 offset:55296
  v_mfma_f32_16x16x32_bf16 v[24:27], v[108:111], v[32:35], v[24:27]
  ds_read_b64_tr_b16 v[124:125], v151 offset:53248
  v_mfma_f32_16x16x32_bf16 v[28:31], v[108:111], v[36:39], v[28:31]
  ds_read_b64_tr_b16 v[126:127], v151 offset:55296
  s_waitcnt vmcnt(4)
  s_waitcnt lgkmcnt(4)
  v_mfma_f32_16x16x32_bf16 v[0:3], v[112:115], v[40:43], v[0:3]
  ds_read_b64_tr_b16 v[96:97], v148 offset:57344
  v_mfma_f32_16x16x32_bf16 v[4:7], v[112:115], v[44:47], v[4:7]
  ds_read_b64_tr_b16 v[98:99], v148 offset:59392
  v_mfma_f32_16x16x32_bf16 v[8:11], v[116:119], v[40:43], v[8:11]
  ds_read_b64_tr_b16 v[100:101], v149 offset:57344
  v_mfma_f32_16x16x32_bf16 v[12:15], v[116:119], v[44:47], v[12:15]
  ds_read_b64_tr_b16 v[102:103], v149 offset:59392
  s_waitcnt lgkmcnt(4)
  v_mfma_f32_16x16x32_bf16 v[16:19], v[120:123], v[40:43], v[16:19]
  ds_read_b64_tr_b16 v[104:105], v150 offset:57344
  v_mfma_f32_16x16x32_bf16 v[20:23], v[120:123], v[44:47], v[20:23]
  ds_read_b64_tr_b16 v[106:107], v150 offset:59392
  v_mfma_f32_16x16x32_bf16 v[24:27], v[124:127], v[40:43], v[24:27]
  ds_read_b64_tr_b16 v[108:109], v151 offset:57344
  v_mfma_f32_16x16x32_bf16 v[28:31], v[124:127], v[44:47], v[28:31]
  ds_read_b64_tr_b16 v[110:111], v151 offset:59392
  s_waitcnt vmcnt(2)
  s_waitcnt lgkmcnt(4)
  v_mfma_f32_16x16x32_bf16 v[0:3], v[96:99], v[48:51], v[0:3]
  ds_read_b64_tr_b16 v[112:113], v148 offset:61440
  v_mfma_f32_16x16x32_bf16 v[4:7], v[96:99], v[52:55], v[4:7]
  ds_read_b64_tr_b16 v[114:115], v148 offset:63488
  v_mfma_f32_16x16x32_bf16 v[8:11], v[100:103], v[48:51], v[8:11]
  ds_read_b64_tr_b16 v[116:117], v149 offset:61440
  v_mfma_f32_16x16x32_bf16 v[12:15], v[100:103], v[52:55], v[12:15]
  ds_read_b64_tr_b16 v[118:119], v149 offset:63488
  s_waitcnt lgkmcnt(4)
  v_mfma_f32_16x16x32_bf16 v[16:19], v[104:107], v[48:51], v[16:19]
  ds_read_b64_tr_b16 v[120:121], v150 offset:61440
  v_mfma_f32_16x16x32_bf16 v[20:23], v[104:107], v[52:55], v[20:23]
  ds_read_b64_tr_b16 v[122:123], v150 offset:63488
  v_mfma_f32_16x16x32_bf16 v[24:27], v[108:111], v[48:51], v[24:27]
  ds_read_b64_tr_b16 v[124:125], v151 offset:61440
  v_mfma_f32_16x16x32_bf16 v[28:31], v[108:111], v[52:55], v[28:31]
  ds_read_b64_tr_b16 v[126:127], v151 offset:63488
  s_waitcnt vmcnt(0)
  s_waitcnt lgkmcnt(4)
  v_mfma_f32_16x16x32_bf16 v[0:3], v[112:115], v[56:59], v[0:3]
  v_mfma_f32_16x16x32_bf16 v[4:7], v[112:115], v[60:63], v[4:7]
  v_mfma_f32_16x16x32_bf16 v[8:11], v[116:119], v[56:59], v[8:11]
  v_mfma_f32_16x16x32_bf16 v[12:15], v[116:119], v[60:63], v[12:15]
  s_waitcnt lgkmcnt(0)
  v_mfma_f32_16x16x32_bf16 v[16:19], v[120:123], v[56:59], v[16:19]
  v_mfma_f32_16x16x32_bf16 v[20:23], v[120:123], v[60:63], v[20:23]
  v_mfma_f32_16x16x32_bf16 v[24:27], v[124:127], v[56:59], v[24:27]
  v_mfma_f32_16x16x32_bf16 v[28:31], v[124:127], v[60:63], v[28:31]
  s_mov_b32 s81, 0
L_lp_34:
  ds_read_b32 v64, v230 offset:52
  s_waitcnt lgkmcnt(0)
  v_readfirstlane_b32 s80, v64
  s_add_u32 s81, s81, 1
  s_cmp_ge_u32 s80, 2
  s_cbranch_scc1 L_lpd_35
  s_cmp_lt_u32 s81, 3200000
  s_cbranch_scc1 L_lp_34
L_lpd_35:
  v_bfe_u32 v64, v250, 2, 2
  v_lshrrev_b32 v65, 4, v250
  v_lshlrev_b32 v65, 2, v65
  v_add_u32 v64, v64, v65
  v_lshlrev_b32 v64, 8, v64
  v_and_b32 v65, 3, v250
  v_lshlrev_b32 v65, 3, v65
  v_add_u32 v64, v64, v65
  s_lshl_b32 s73, s64, 6
  s_add_u32 s73, s73, 132096
  v_add_u32 v64, s73, v64
  ds_read_b64_tr_b16 v[32:33], v64 offset:0
  ds_read_b64_tr_b16 v[34:35], v64 offset:32
  ds_read_b64_tr_b16 v[36:37], v64 offset:4096
  ds_read_b64_tr_b16 v[38:39], v64 offset:4128
  ds_read_b64_tr_b16 v[40:41], v64 offset:8192
  ds_read_b64_tr_b16 v[42:43], v64 offset:8224
  ds_read_b64_tr_b16 v[44:45], v64 offset:12288
  ds_read_b64_tr_b16 v[46:47], v64 offset:12320
  s_waitcnt lgkmcnt(0)
  v_lshlrev_b32 v66, 16, v32
  v_and_b32 v67, 0xffff0000, v32
  v_lshlrev_b32 v68, 16, v33
  v_and_b32 v69, 0xffff0000, v33
  v_mul_f32 v66, v66, v160
  v_mul_f32 v67, v67, v161
  v_mul_f32 v68, v68, v162
  v_mul_f32 v69, v69, v163
  v_fmac_f32 v66, v0, v144
  v_fmac_f32 v67, v1, v144
  v_fmac_f32 v68, v2, v144
  v_fmac_f32 v69, v3, v144
  v_cvt_pk_bf16_f32 v80, v66, v67
  v_cvt_pk_bf16_f32 v81, v68, v69
  v_lshlrev_b32 v72, 16, v36
  v_and_b32 v73, 0xffff0000, v36
  v_lshlrev_b32 v74, 16, v37
  v_and_b32 v75, 0xffff0000, v37
  v_mul_f32 v72, v72, v164
  v_mul_f32 v73, v73, v165
  v_mul_f32 v74, v74, v166
  v_mul_f32 v75, v75, v167
  v_fmac_f32 v72, v8, v144
  v_fmac_f32 v73, v9, v144
  v_fmac_f32 v74, v10, v144
  v_fmac_f32 v75, v11, v144
  v_cvt_pk_bf16_f32 v82, v72, v73
  v_cvt_pk_bf16_f32 v83, v74, v75
  v_lshlrev_b32 v66, 16, v40
  v_and_b32 v67, 0xffff0000, v40
  v_lshlrev_b32 v68, 16, v41
  v_and_b32 v69, 0xffff0000, v41
  v_mul_f32 v66, v66, v168
  v_mul_f32 v67, v67, v169
  v_mul_f32 v68, v68, v170
  v_mul_f32 v69, v69, v171
  v_fmac_f32 v66, v16, v144
  v_fmac_f32 v67, v17, v144
  v_fmac_f32 v68, v18, v144
  v_fmac_f32 v69, v19, v144
  v_cvt_pk_bf16_f32 v84, v66, v67
  v_cvt_pk_bf16_f32 v85, v68, v69
  v_lshlrev_b32 v72, 16, v44
  v_and_b32 v73, 0xffff0000, v44
  v_lshlrev_b32 v74, 16, v45
  v_and_b32 v75, 0xffff0000, v45
  v_mul_f32 v72, v72, v172
  v_mul_f32 v73, v73, v173
  v_mul_f32 v74, v74, v174
  v_mul_f32 v75, v75, v175
  v_fmac_f32 v72, v24, v144
  v_fmac_f32 v73, v25, v144
  v_fmac_f32 v74, v26, v144
  v_fmac_f32 v75, v27, v144
  v_cvt_pk_bf16_f32 v86, v72, v73
  v_cvt_pk_bf16_f32 v87, v74, v75
  v_lshlrev_b32 v66, 16, v34
  v_and_b32 v67, 0xffff0000, v34
  v_lshlrev_b32 v68, 16, v35
  v_and_b32 v69, 0xffff0000, v35
  v_mul_f32 v66, v66, v176
  v_mul_f32 v67, v67, v177
  v_mul_f32 v68, v68, v178
  v_mul_f32 v69, v69, v179
  v_fmac_f32 v66, v4, v145
  v_fmac_f32 v67, v5, v145
  v_fmac_f32 v68, v6, v145
  v_fmac_f32 v69, v7, v145
  v_cvt_pk_bf16_f32 v88, v66, v67
  v_cvt_pk_bf16_f32 v89, v68, v69
  v_lshlrev_b32 v72, 16, v38
  v_and_b32 v73, 0xffff0000, v38
  v_lshlrev_b32 v74, 16, v39
  v_and_b32 v75, 0xffff0000, v39
  v_mul_f32 v72, v72, v180
  v_mul_f32 v73, v73, v181
  v_mul_f32 v74, v74, v182
  v_mul_f32 v75, v75, v183
  v_fmac_f32 v72, v12, v145
  v_fmac_f32 v73, v13, v145
  v_fmac_f32 v74, v14, v145
  v_fmac_f32 v75, v15, v145
  v_cvt_pk_bf16_f32 v90, v72, v73
  v_cvt_pk_bf16_f32 v91, v74, v75
  v_lshlrev_b32 v66, 16, v42
  v_and_b32 v67, 0xffff0000, v42
  v_lshlrev_b32 v68, 16, v43
  v_and_b32 v69, 0xffff0000, v43
  v_mul_f32 v66, v66, v184
  v_mul_f32 v67, v67, v185
  v_mul_f32 v68, v68, v186
  v_mul_f32 v69, v69, v187
  v_fmac_f32 v66, v20, v145
  v_fmac_f32 v67, v21, v145
  v_fmac_f32 v68, v22, v145
  v_fmac_f32 v69, v23, v145
  v_cvt_pk_bf16_f32 v92, v66, v67
  v_cvt_pk_bf16_f32 v93, v68, v69
  v_lshlrev_b32 v72, 16, v46
  v_and_b32 v73, 0xffff0000, v46
  v_lshlrev_b32 v74, 16, v47
  v_and_b32 v75, 0xffff0000, v47
  v_mul_f32 v72, v72, v188
  v_mul_f32 v73, v73, v189
  v_mul_f32 v74, v74, v190
  v_mul_f32 v75, v75, v191
  v_fmac_f32 v72, v28, v145
  v_fmac_f32 v73, v29, v145
  v_fmac_f32 v74, v30, v145
  v_fmac_f32 v75, v31, v145
  v_cvt_pk_bf16_f32 v94, v72, v73
  v_cvt_pk_bf16_f32 v95, v74, v75
  s_nop 1
  v_permlane32_swap_b32 v80, v82
  v_permlane32_swap_b32 v81, v83
  v_permlane32_swap_b32 v84, v86
  v_permlane32_swap_b32 v85, v87
  v_permlane32_swap_b32 v88, v90
  v_permlane32_swap_b32 v89, v91
  v_permlane32_swap_b32 v92, v94
  v_permlane32_swap_b32 v93, v95
  s_nop 0
  v_permlane16_swap_b32 v80, v82
  v_permlane16_swap_b32 v81, v83
  v_permlane16_swap_b32 v84, v86
  v_permlane16_swap_b32 v85, v87
  v_permlane16_swap_b32 v88, v90
  v_permlane16_swap_b32 v89, v91
  v_permlane16_swap_b32 v92, v94
  v_permlane16_swap_b32 v93, v95
  buffer_store_dwordx4 v[80:83], v192, s[52:55], 0 offen offset:0 sc1
  buffer_store_dwordx4 v[84:87], v192, s[52:55], 0 offen offset:64 sc1
  buffer_store_dwordx4 v[88:91], v193, s[52:55], 0 offen offset:0 sc1
  buffer_store_dwordx4 v[92:95], v193, s[52:55], 0 offen offset:64 sc1
L_end:
  s_endpgm
.section .rodata,"a"
.p2align 6
.amdhsa_kernel gated_mix__linear_attn_block__ssm_conv_h3__prompt_kernel
  .amdhsa_next_free_vgpr 256
  .amdhsa_next_free_sgpr 102
  .amdhsa_accum_offset 256
  .amdhsa_group_segment_fixed_size 0
  .amdhsa_kernarg_size 104
  .amdhsa_user_sgpr_count 2
  .amdhsa_user_sgpr_kernarg_segment_ptr 1
  .amdhsa_system_sgpr_workgroup_id_x 1
  .amdhsa_float_denorm_mode_32 3
.end_amdhsa_kernel
```
